```python
import torch

def _softmax(x, axis=-1):
    return torch.softmax(x, dim=axis)
def _gelu(x):
    return torch.nn.functional.gelu(x, approximate="tanh")
def _silu(x):
    return torch.nn.functional.silu(x)
def _sigmoid(x):
    return torch.sigmoid(x)
def _layernorm(x, axis=-1, eps=1e-5):
    m = x.mean(dim=axis, keepdim=True)
    v = x.var(dim=axis, keepdim=True, unbiased=False)
    return (x - m) / torch.sqrt(v + eps)
def _scatter_add(tgt, idx, src, axis=0):
    return tgt.clone().index_add_(axis, idx, src)
def _segment_sum(src, seg, n):
    out = torch.zeros((n,) + src.shape[1:], dtype=src.dtype)
    return out.index_add_(0, seg, src)
def _pad(x, pw):
    flat = tuple(v for pair in reversed(pw) for v in pair)
    return torch.nn.functional.pad(x, flat)

kernel_name = 'concat_heads__sliding_block_cached__compressed_kv_cla__decode'

def setup_inputs():

    _w = (lambda a: (lambda t: t.to(torch.bfloat16) if t.is_floating_point() else t)(torch.as_tensor(a)))
    def _A_setup():
        B, Sq, D = 2, 1, 576
        Hq, Hkv, Sk, Dh = 32, 16, 8192, 128
        assert Hq % Hkv == 0, (Hq, Hkv)
        return {
            "x": _w((lambda *s: torch.randn(*s, dtype=torch.bfloat16) * 1.6)(B, Sq, D)),
            "k_cache": _w((lambda *s: torch.randn(*s, dtype=torch.bfloat16) * 1.6)(B, Hkv, Sk, Dh)),
            "v_cache": _w((lambda *s: torch.randn(*s, dtype=torch.bfloat16) * 0.05)(B, Hkv, Sk, Dh)),
            "wq": _w((lambda *s: torch.randn(*s, dtype=torch.bfloat16) * 1.6)(D, Hq * Dh) * (D ** -0.5)),
            "wo": _w((lambda *s: torch.randn(*s, dtype=torch.bfloat16) * 0.05)(Hq * Dh, D) * ((Hq * Dh) ** -0.5)),
        }
    _A_in = _A_setup()

    def _B_setup():
        B, H, Sq, Sk, D, M = 2, 32, 1, 8192, 128, 576
        Dc = 4 * D
        return {
            "x": _w((lambda *s: torch.randn(*s, dtype=torch.bfloat16) * 3.2)(B, Sq, M)),
            "c_kv": _w((lambda *s: torch.randn(*s, dtype=torch.bfloat16) * 0.1)(B, Sk, Dc)),
            "w_q": _w((lambda *s: torch.randn(*s, dtype=torch.bfloat16) * 6.4)(M, H, D) * (M ** -0.5)),
            "w_uk": _w((lambda *s: torch.randn(*s, dtype=torch.bfloat16) * 6.4)(Dc, H, D) * (Dc ** -0.5)),
            "w_uv": _w((lambda *s: torch.randn(*s, dtype=torch.bfloat16) * 0.1)(Dc, H, D) * (Dc ** -0.5)),
            "w_o": _w((lambda *s: torch.randn(*s, dtype=torch.bfloat16) * 0.1)(H, D, M) * ((H * D) ** -0.5)),
        }
    _B_in = _B_setup()

    return {
        "A_x": _A_in["x"],
        "A_k_cache": _A_in["k_cache"],
        "A_v_cache": _A_in["v_cache"],
        "A_wq": _A_in["wq"],
        "A_wo": _A_in["wo"],
        "B_x": _B_in["x"],
        "B_c_kv": _B_in["c_kv"],
        "B_w_q": _B_in["w_q"],
        "B_w_uk": _B_in["w_uk"],
        "B_w_uv": _B_in["w_uv"],
        "B_w_o": _B_in["w_o"],
    }

def reference(A_x, A_k_cache, A_v_cache, A_wq, A_wo, B_x, B_c_kv, B_w_q, B_w_uk, B_w_uv, B_w_o):
    def _A_ref(x, k_cache, v_cache, wq, wo):
        B, Sq, D = x.shape
        Hq, Dh = 32, 128
        Hkv, Sk = k_cache.shape[1], k_cache.shape[2]
        W = min(4096, max(256, Sk // 4))
        rep = Hq // Hkv
        q = (lambda x, *d: x.permute(*d))((x @ wq).reshape(B, Sq, Hq, Dh), 0, 2, 1, 3)
        k = (lambda x, n, axis: torch.repeat_interleave(x, n, dim=axis))(k_cache[:, :, Sk - W:, :], rep, axis=1)
        v = (lambda x, n, axis: torch.repeat_interleave(x, n, dim=axis))(v_cache[:, :, Sk - W:, :], rep, axis=1)
        scores = torch.einsum("bhqd,bhkd->bhqk", q, k) * (Dh ** -0.5)
        p = _softmax(scores, axis=-1)
        o = torch.einsum("bhqk,bhkd->bhqd", p, v)
        return (lambda x, *d: x.permute(*d))(o, 0, 2, 1, 3).reshape(B, Sq, Hq * Dh) @ wo

    def _B_ref(x, c_kv, w_q, w_uk, w_uv, w_o):
        B, Sq, M = x.shape[0], x.shape[1], x.shape[2]
        Sk = c_kv.shape[1]
        H, D = w_q.shape[1], w_q.shape[2]
        q = torch.einsum("bqm,mhd->bhqd", x, w_q)
        k = torch.einsum("bkc,chd->bhkd", c_kv, w_uk)
        v = torch.einsum("bkc,chd->bhkd", c_kv, w_uv)
        scores = torch.einsum("bhqd,bhkd->bhqk", q, k) * (D ** -0.5)
        off = Sk - Sq
        qi = torch.arange(Sq)[:, None]
        kj = torch.arange(Sk)[None, :]
        cmask = kj <= (qi + off)
        scores = torch.where(cmask[None, None], scores, -1e9)
        p = _softmax(scores, axis=-1)
        ctx = torch.einsum("bhqk,bhkd->bhqd", p, v)
        return torch.einsum("bhqd,hdm->bqm", ctx, w_o)

    a = _A_ref(A_x, A_k_cache, A_v_cache, A_wq, A_wo)
    b = _B_ref(B_x, B_c_kv, B_w_q, B_w_uk, B_w_uv, B_w_o)
    return torch.concatenate([a, b], axis=-1)
```

```asm
; @launch grid=(256,1,1) block=(256,1,1) lds=163840
.amdgcn_target "amdgcn-amd-amdhsa--gfx950"
.text
.globl concat_heads__sliding_block_cached__compressed_kv_cla__decode_kernel
.p2align 8
.type concat_heads__sliding_block_cached__compressed_kv_cla__decode_kernel,@function
concat_heads__sliding_block_cached__compressed_kv_cla__decode_kernel:
    s_cmp_ge_u32 s2, 256
    s_cbranch_scc1 L_end
    s_load_dwordx16 s[36:51], s[0:1], 0
    s_load_dwordx8 s[52:59], s[0:1], 64
    s_load_dwordx4 s[60:63], s[0:1], 96
    v_and_b32 v1, 63, v0
    v_lshrrev_b32 v17, 6, v0
    v_and_b32 v2, 15, v0
    v_bfe_u32 v3, v0, 4, 2
    v_readfirstlane_b32 s3, v17
    v_bfe_u32 v13, v0, 3, 1
    v_mul_u32_u24 v20, 1152, v13
    v_mul_u32_u24 v17, 18, v3
    v_add_u32 v20, v20, v17
    v_mul_u32_u24 v21, 73728, v3
    v_lshlrev_b32 v17, 4, v2
    v_add_u32 v21, v21, v17
    v_lshlrev_b32 v31, 4, v1
    s_waitcnt lgkmcnt(0)
    s_load_dword s64, s[62:63], 0
    s_cmp_ge_u32 s2, 128
    s_mov_b32 s100, s42
    s_mov_b32 s101, s43
    s_mov_b32 s4, s62
    s_mov_b32 s5, s63
    s_mov_b32 s6, 0x10000000
    s_mov_b32 s7, 0x20000
    s_mov_b32 s8, s46
    s_mov_b32 s9, s47
    s_mov_b32 s10, 2304
    s_mov_b32 s11, 0x20000
    s_mov_b32 s12, s50
    s_mov_b32 s13, s51
    s_mov_b32 s14, 4718592
    s_mov_b32 s15, 0x20000
    s_cselect_b32 s16, s48, s38
    s_cselect_b32 s17, s49, s39
    s_mov_b32 s18, 67108864
    s_cselect_b32 s18, 16777216, s18
    s_mov_b32 s19, 0x20000
    s_cselect_b32 s20, s54, s52
    s_cselect_b32 s21, s55, s53
    s_mov_b32 s22, 4194304
    s_mov_b32 s23, 0x20000
    s_cselect_b32 s24, s56, s44
    s_cselect_b32 s25, s57, s45
    s_mov_b32 s26, 4718592
    s_mov_b32 s27, 0x20000
    s_mov_b32 s28, s58
    s_mov_b32 s29, s59
    s_mov_b32 s30, 4608
    s_mov_b32 s31, 0x20000
    s_and_b32 s42, s2, 7
    s_bfe_u32 s43, s2, 0x20003
    s_bfe_u32 s44, s2, 0x20005
    s_lshl_b32 s44, s44, 3
    s_add_u32 s44, s44, s42
    s_lshl_b32 s44, s44, 2
    s_add_u32 s44, s44, s43
    s_bfe_u32 s45, s2, 0x10006
    s_lshl_b32 s45, s45, 3
    s_add_u32 s45, s45, s42
    s_bfe_u32 s42, s2, 0x10005
    s_lshl_b32 s62, s42, 6
    s_lshl_b32 s63, s45, 2
    s_add_u32 s62, s62, s63
    s_add_u32 s62, s62, s43
    s_lshl_b32 s45, s45, 1
    s_add_u32 s45, s45, s42
    s_lshl_b32 s45, s45, 2
    s_add_u32 s45, s45, s43
    s_cmp_ge_u32 s2, 128
    s_mov_b32 s59, s44
    s_cselect_b32 s63, s44, s45
    s_and_b32 s42, s63, 3
    s_cmp_eq_u32 s42, 3
    s_cselect_b32 s26, 0, s26
    s_lshr_b32 s49, s59, 2
    s_lshr_b32 s54, s2, 7
    s_mov_b32 s65, 0
    s_and_b32 s42, s59, 3
    s_mul_i32 s42, s42, 144
    s_mul_i32 s43, s3, 36
    s_add_u32 s42, s42, s43
    s_lshl_b32 s56, s42, 1
    s_lshl_b32 s55, s42, 13
    s_lshl_b32 s43, s49, 8
    s_add_u32 s55, s55, s43
    v_xor_b32 v17, v2, v3
    v_lshlrev_b32 v17, 4, v17
    v_lshl_add_u32 v206, v3, 13, v17
    v_xor_b32 v207, 64, v206
    v_xor_b32 v208, 128, v206
    v_xor_b32 v209, 192, v206
    s_cmp_ge_u32 s2, 128
    s_cbranch_scc1 L_roleB
    s_add_u32 s44, s55, 0
    buffer_load_dwordx4 v[32:35], v21, s[12:15], s44 offen nt
    buffer_load_ushort v22, v20, s[8:11], s56 offen offset:0
    buffer_load_ushort v23, v20, s[8:11], s56 offen offset:2
    buffer_load_ushort v24, v20, s[8:11], s56 offen offset:4
    buffer_load_ushort v25, v20, s[8:11], s56 offen offset:6
    buffer_load_ushort v26, v20, s[8:11], s56 offen offset:8
    buffer_load_ushort v27, v20, s[8:11], s56 offen offset:10
    buffer_load_ushort v28, v20, s[8:11], s56 offen offset:12
    buffer_load_ushort v29, v20, s[8:11], s56 offen offset:14
    buffer_load_ushort v30, v20, s[8:11], s56 offen offset:16
    s_add_u32 s44, s55, 8192
    buffer_load_dwordx4 v[36:39], v21, s[12:15], s44 offen nt
    s_add_u32 s44, s55, 16384
    buffer_load_dwordx4 v[40:43], v21, s[12:15], s44 offen nt
    s_add_u32 s44, s55, 24576
    buffer_load_dwordx4 v[44:47], v21, s[12:15], s44 offen nt
    s_add_u32 s44, s55, 32768
    buffer_load_dwordx4 v[48:51], v21, s[12:15], s44 offen nt
    s_add_u32 s44, s55, 40960
    buffer_load_dwordx4 v[52:55], v21, s[12:15], s44 offen nt
    s_add_u32 s44, s55, 49152
    buffer_load_dwordx4 v[56:59], v21, s[12:15], s44 offen nt
    s_add_u32 s44, s55, 57344
    buffer_load_dwordx4 v[60:63], v21, s[12:15], s44 offen nt
    s_add_u32 s44, s55, 65536
    buffer_load_dwordx4 v[64:67], v21, s[12:15], s44 offen nt
    s_and_b32 s51, s59, 3
    s_lshl_b32 s51, s51, 7
    s_lshl_b32 s43, s3, 5
    s_add_u32 s51, s51, s43
    s_lshl_b32 s51, s51, 13
    s_lshl_b32 s43, s49, 8
    s_add_u32 s51, s51, s43
    s_lshl_b32 s52, s3, 15
    v_and_b32 v17, 1, v1
    v_cmp_eq_u32 vcc, 1, v17
    v_mov_b32 v18, 0x0c0c0100
    v_mov_b32 v19, 0x01000c0c
    v_cndmask_b32 v68, v18, v19, vcc
    v_mov_b32 v18, 0x0c0c0302
    v_mov_b32 v19, 0x03020c0c
    v_cndmask_b32 v69, v18, v19, vcc
    v_bfe_u32 v17, v1, 1, 2
    v_mov_b32 v18, 0x0c0c0c0c
    v_cmp_eq_u32 vcc, 0, v17
    s_nop 1
    v_cndmask_b32 v4, v18, v68, vcc
    v_cndmask_b32 v8, v18, v69, vcc
    v_cmp_eq_u32 vcc, 1, v17
    s_nop 1
    v_cndmask_b32 v5, v18, v68, vcc
    v_cndmask_b32 v9, v18, v69, vcc
    v_cmp_eq_u32 vcc, 2, v17
    s_nop 1
    v_cndmask_b32 v6, v18, v68, vcc
    v_cndmask_b32 v10, v18, v69, vcc
    v_cmp_eq_u32 vcc, 3, v17
    s_nop 1
    v_cndmask_b32 v7, v18, v68, vcc
    v_cndmask_b32 v11, v18, v69, vcc
    v_lshlrev_b32 v15, 2, v0
    v_add_u32 v15, 131072, v15
    v_lshlrev_b32 v16, 3, v0
    v_lshlrev_b32 v14, 9, v13
    v_lshl_add_u32 v14, v3, 7, v14
    v_and_b32 v17, 7, v1
    v_lshl_add_u32 v14, v17, 2, v14
    s_lshl_b32 s42, s3, 10
    s_add_u32 s42, s42, 131072
    v_add_u32 v14, s42, v14
    v_lshlrev_b32 v85, 3, v1
    s_mov_b32 s58, 0x3e0293ee
    s_waitcnt lgkmcnt(0)
    s_mul_i32 s46, s64, 0x9E3779B1
    s_add_u32 s46, s46, 0x7F4A7C15
    v_mov_b32 v12, s46
    s_and_b32 s42, s2, 7
    s_lshl_b32 s42, s42, 7
    s_lshr_b32 s43, s2, 3
    s_lshl_b32 s43, s43, 2
    s_add_u32 s42, s42, s43
    s_add_u32 s42, s42, 1540096
    v_mov_b32 v17, 0
    v_cmp_eq_u32 vcc, 0, v0
    s_nop 0
    s_and_saveexec_b64 s[32:33], vcc
    s_cbranch_execz L_nohello_1
    buffer_store_dword v12, v17, s[4:7], s42 offen
L_nohello_1:
    s_mov_b64 exec, s[32:33]
    s_lshr_b32 s42, s62, 2
    s_lshl_b32 s47, s42, 21
    s_and_b32 s42, s62, 3
    s_lshl_b32 s42, s42, 17
    s_add_u32 s47, s47, s42
    s_add_u32 s47, s47, 1572864
    s_lshl_b32 s42, s3, 15
    s_add_u32 s47, s47, s42
    v_xor_b32 v17, v2, v3
    v_lshlrev_b32 v17, 4, v17
    v_lshl_add_u32 v200, v3, 8, v17
    v_xor_b32 v201, 64, v200
    v_xor_b32 v202, 128, v200
    v_xor_b32 v203, 192, v200
    v_lshlrev_b32 v17, 4, v2
    v_lshl_add_u32 v204, v3, 10, v17
    s_mul_i32 s57, s2, 5
    s_mul_i32 s42, s3, 3
    s_add_u32 s57, s57, s42
    s_add_u32 s42, s49, 32
    s_lshl_b32 s0, s42, 13
    s_lshl_b32 s42, s3, 9
    s_add_u32 s0, s0, s42
    s_add_u32 s0, s0, 4096
    s_add_u32 s50, s0, 16777216
    v_add_u32 v17, 0, v3
    v_xor_b32 v17, v17, v2
    v_lshlrev_b32 v17, 4, v17
    v_lshl_add_u32 v112, v2, 8, v17
    v_add_u32 v17, 4, v3
    v_xor_b32 v17, v17, v2
    v_lshlrev_b32 v17, 4, v17
    v_lshl_add_u32 v113, v2, 8, v17
    v_add_u32 v17, 8, v3
    v_xor_b32 v17, v17, v2
    v_lshlrev_b32 v17, 4, v17
    v_lshl_add_u32 v114, v2, 8, v17
    v_add_u32 v17, 12, v3
    v_xor_b32 v17, v17, v2
    v_lshlrev_b32 v17, 4, v17
    v_lshl_add_u32 v115, v2, 8, v17
    s_lshl_b32 s42, s3, 15
    v_add_u32 v112, s42, v112
    v_add_u32 v113, s42, v113
    v_add_u32 v114, s42, v114
    v_add_u32 v115, s42, v115
    s_waitcnt vmcnt(8)
    v_perm_b32 v72, v22, v22, v4
    v_perm_b32 v73, v22, v22, v5
    v_perm_b32 v74, v22, v22, v6
    v_perm_b32 v75, v22, v22, v7
    v_perm_b32 v76, v23, v23, v4
    v_perm_b32 v77, v23, v23, v5
    v_perm_b32 v78, v23, v23, v6
    v_perm_b32 v79, v23, v23, v7
    v_mfma_f32_16x16x32_bf16 v[68:71], v[32:35], v[72:75], 0
    s_add_u32 m0, s52, 24576
    s_add_u32 s44, s51, 0
    buffer_load_dwordx4 v206, s[20:23], s44 offen nt lds
    v_perm_b32 v72, v24, v24, v4
    v_perm_b32 v73, v24, v24, v5
    v_perm_b32 v74, v24, v24, v6
    v_perm_b32 v75, v24, v24, v7
    s_waitcnt vmcnt(8)
    v_mfma_f32_16x16x32_bf16 v[68:71], v[36:39], v[76:79], v[68:71]
    s_add_u32 m0, s52, 25600
    s_add_u32 s44, s51, 32768
    buffer_load_dwordx4 v207, s[20:23], s44 offen nt lds
    v_perm_b32 v76, v25, v25, v4
    v_perm_b32 v77, v25, v25, v5
    v_perm_b32 v78, v25, v25, v6
    v_perm_b32 v79, v25, v25, v7
    s_waitcnt vmcnt(8)
    v_mfma_f32_16x16x32_bf16 v[68:71], v[40:43], v[72:75], v[68:71]
    s_add_u32 m0, s52, 26624
    s_add_u32 s44, s51, 65536
    buffer_load_dwordx4 v208, s[20:23], s44 offen nt lds
    v_perm_b32 v72, v26, v26, v4
    v_perm_b32 v73, v26, v26, v5
    v_perm_b32 v74, v26, v26, v6
    v_perm_b32 v75, v26, v26, v7
    s_waitcnt vmcnt(8)
    v_mfma_f32_16x16x32_bf16 v[68:71], v[44:47], v[76:79], v[68:71]
    s_add_u32 m0, s52, 27648
    s_add_u32 s44, s51, 98304
    buffer_load_dwordx4 v209, s[20:23], s44 offen nt lds
    v_perm_b32 v76, v27, v27, v4
    v_perm_b32 v77, v27, v27, v5
    v_perm_b32 v78, v27, v27, v6
    v_perm_b32 v79, v27, v27, v7
    s_waitcnt vmcnt(8)
    v_mfma_f32_16x16x32_bf16 v[68:71], v[48:51], v[72:75], v[68:71]
    s_add_u32 m0, s52, 28672
    s_add_u32 s44, s51, 131072
    buffer_load_dwordx4 v206, s[20:23], s44 offen nt lds
    v_perm_b32 v72, v28, v28, v4
    v_perm_b32 v73, v28, v28, v5
    v_perm_b32 v74, v28, v28, v6
    v_perm_b32 v75, v28, v28, v7
    s_waitcnt vmcnt(8)
    v_mfma_f32_16x16x32_bf16 v[68:71], v[52:55], v[76:79], v[68:71]
    s_add_u32 m0, s52, 29696
    s_add_u32 s44, s51, 163840
    buffer_load_dwordx4 v207, s[20:23], s44 offen nt lds
    v_perm_b32 v76, v29, v29, v4
    v_perm_b32 v77, v29, v29, v5
    v_perm_b32 v78, v29, v29, v6
    v_perm_b32 v79, v29, v29, v7
    s_waitcnt vmcnt(8)
    v_mfma_f32_16x16x32_bf16 v[68:71], v[56:59], v[72:75], v[68:71]
    s_add_u32 m0, s52, 30720
    s_add_u32 s44, s51, 196608
    buffer_load_dwordx4 v208, s[20:23], s44 offen nt lds
    v_perm_b32 v72, v30, v30, v4
    v_perm_b32 v73, v30, v30, v5
    v_perm_b32 v74, v30, v30, v6
    v_perm_b32 v75, v30, v30, v7
    s_waitcnt vmcnt(8)
    v_mfma_f32_16x16x32_bf16 v[68:71], v[60:63], v[76:79], v[68:71]
    s_add_u32 m0, s52, 31744
    s_add_u32 s44, s51, 229376
    buffer_load_dwordx4 v209, s[20:23], s44 offen nt lds
    s_waitcnt vmcnt(8)
    v_mfma_f32_16x16x32_bf16 v[68:71], v[64:67], v[72:75], v[68:71]
    s_nop 7
    ds_write_b32 v14, v68 offset:0
    ds_write_b32 v14, v69 offset:32
    ds_write_b32 v14, v70 offset:64
    ds_write_b32 v14, v71 offset:96
    v_mov_b32 v81, v12
    s_lshl_b32 s42, s59, 11
    s_add_u32 s42, s42, 266240
    s_add_u32 s43, s42, 16777216
    s_and_b32 s44, s2, 7
    s_lshl_b32 s44, s44, 7
    s_lshr_b32 s45, s2, 7
    s_lshl_b32 s45, s45, 6
    s_add_u32 s44, s44, s45
    s_add_u32 s44, s44, 1540096
    v_lshlrev_b32 v82, 2, v2
    buffer_load_dword v83, v82, s[4:7], s44 offen sc1
    s_waitcnt lgkmcnt(0)
    s_barrier
    ds_read_b32 v72, v15 offset:0
    ds_read_b32 v73, v15 offset:1024
    ds_read_b32 v74, v15 offset:2048
    ds_read_b32 v75, v15 offset:3072
    s_waitcnt lgkmcnt(0)
    v_add_f32 v72, v72, v73
    v_add_f32 v74, v74, v75
    v_add_f32 v80, v72, v74
    buffer_store_dwordx2 v[80:81], v16, s[4:7], s43 offen
    buffer_store_dwordx2 v[80:81], v16, s[4:7], s42 offen sc1
    s_add_u32 s45, s50, 4096
    buffer_load_dwordx2 v[86:87], v85, s[4:7], s50 offen sc1
    buffer_load_dwordx2 v[88:89], v85, s[4:7], s50 offen offset:2048 sc1
    buffer_load_dwordx2 v[90:91], v85, s[4:7], s45 offen sc1
    buffer_load_dwordx2 v[92:93], v85, s[4:7], s45 offen offset:2048 sc1
    s_waitcnt vmcnt(0)
    v_cmp_ne_u32 vcc, v12, v83
    s_mov_b32 s65, 16777216
    s_nop 0
    s_cmp_eq_u64 vcc, 0
    s_cselect_b32 s65, s65, 0
    s_mov_b32 s48, 3000000
L_chk_2:
    s_mov_b64 s[32:33], exec
    v_cmpx_eq_u32 vcc, v12, v87
    v_cmpx_eq_u32 vcc, v12, v89
    v_cmpx_eq_u32 vcc, v12, v91
    v_cmpx_eq_u32 vcc, v12, v93
    s_nop 3
    s_cmp_eq_u64 exec, s[32:33]
    s_mov_b64 exec, s[32:33]
    s_cbranch_scc1 L_ok_3
    s_sub_u32 s48, s48, 1
    s_cmp_eq_u32 s48, 0
    s_cbranch_scc1 L_to_4
    s_cmp_lt_u32 s48, 2999744
    s_cselect_b32 s65, 0, s65
    s_add_u32 s50, s0, s65
    s_and_b32 s44, s2, 7
    s_lshl_b32 s44, s44, 7
    s_lshr_b32 s45, s2, 7
    s_lshl_b32 s45, s45, 6
    s_add_u32 s44, s44, s45
    s_add_u32 s44, s44, 1540096
    v_lshlrev_b32 v82, 2, v2
    buffer_load_dword v83, v82, s[4:7], s44 offen sc1
    s_add_u32 s45, s50, 4096
    buffer_load_dwordx2 v[86:87], v85, s[4:7], s50 offen sc1
    buffer_load_dwordx2 v[88:89], v85, s[4:7], s50 offen offset:2048 sc1
    buffer_load_dwordx2 v[90:91], v85, s[4:7], s45 offen sc1
    buffer_load_dwordx2 v[92:93], v85, s[4:7], s45 offen offset:2048 sc1
    s_waitcnt vmcnt(0)
    s_waitcnt vmcnt(4)
    v_cmp_ne_u32 vcc, v12, v83
    s_mov_b32 s65, 16777216
    s_nop 0
    s_cmp_eq_u64 vcc, 0
    s_cselect_b32 s65, s65, 0
    s_branch L_chk_2
L_to_4:
    s_mov_b32 s32, s60
    s_mov_b32 s33, s61
    s_mov_b32 s34, 256
    s_mov_b32 s35, 0x20000
    v_mov_b32 v17, 4
    v_mov_b32 v18, 1
    buffer_store_dword v18, v17, s[32:35], 0 offen
    s_waitcnt vmcnt(0)
L_ok_3:
    ds_read_b128 v[116:119], v112 offset:24576
    ds_read_b128 v[120:123], v113 offset:24576
    ds_read_b128 v[124:127], v114 offset:24576
    ds_read_b128 v[128:131], v115 offset:24576
    ds_read_b128 v[132:135], v112 offset:28672
    ds_read_b128 v[136:139], v113 offset:28672
    ds_read_b128 v[140:143], v114 offset:28672
    ds_read_b128 v[144:147], v115 offset:28672
    v_add_f32 v86, v86, v88
    v_add_f32 v90, v90, v92
    v_lshlrev_b32 v17, 1, v0
    v_add_f32 v86, v86, v90
    v_add_u32 v17, 131072, v17
    v_cvt_pk_bf16_f32 v86, v86, v86
    ds_write_b16 v17, v86 offset:4096
    v_lshlrev_b32 v17, 8, v13
    v_lshl_add_u32 v17, v3, 4, v17
    v_add_u32 v17, 131072, v17
    s_waitcnt lgkmcnt(0)
    s_barrier
    ds_read_b128 v[96:99], v17 offset:4096
    ds_read_b128 v[100:103], v17 offset:4160
    ds_read_b128 v[104:107], v17 offset:4224
    ds_read_b128 v[108:111], v17 offset:4288
    v_lshlrev_b32 v17, 16, v13
    v_lshl_add_u32 v17, v3, 4, v17
    s_lshl_b32 s42, s49, 11
    s_and_b32 s43, s59, 3
    s_lshl_b32 s43, s43, 9
    s_add_u32 s42, s42, s43
    s_lshl_b32 s43, s3, 7
    s_add_u32 s42, s42, s43
    s_add_u32 s42, s42, 589824
    v_mov_b32 v81, v12
    v_mov_b32 v83, v12
    v_mov_b32 v89, v12
    v_mov_b32 v91, v12
    v_and_b32 v18, 7, v1
    v_cmp_eq_u32 vcc, 0, v18
    s_waitcnt lgkmcnt(0)
    v_mfma_f32_16x16x32_bf16 v[68:71], v[116:119], v[96:99], 0
    v_mfma_f32_16x16x32_bf16 v[72:75], v[132:135], v[96:99], 0
    v_mfma_f32_16x16x32_bf16 v[68:71], v[120:123], v[100:103], v[68:71]
    v_mfma_f32_16x16x32_bf16 v[72:75], v[136:139], v[100:103], v[72:75]
    v_mfma_f32_16x16x32_bf16 v[68:71], v[124:127], v[104:107], v[68:71]
    v_mfma_f32_16x16x32_bf16 v[72:75], v[140:143], v[104:107], v[72:75]
    v_mfma_f32_16x16x32_bf16 v[68:71], v[128:131], v[108:111], v[68:71]
    v_mfma_f32_16x16x32_bf16 v[72:75], v[144:147], v[108:111], v[72:75]
    s_nop 6
    v_cvt_pk_bf16_f32 v80, v68, v69
    v_cvt_pk_bf16_f32 v82, v70, v71
    v_cvt_pk_bf16_f32 v88, v72, v73
    v_cvt_pk_bf16_f32 v90, v74, v75
    s_and_saveexec_b64 s[32:33], vcc
    buffer_store_dwordx4 v[80:83], v17, s[4:7], s42 offen sc1
    buffer_store_dwordx4 v[88:91], v17, s[4:7], s42 offen offset:64 sc1
    s_mov_b64 exec, s[32:33]
    s_mov_b32 s20, s40
    s_mov_b32 s21, s41
    s_mov_b32 s22, 67108864
    s_mov_b32 s8, s36
    s_mov_b32 s9, s37
    s_mov_b32 s12, s100
    s_mov_b32 s13, s101
    s_and_b32 s42, s63, 3
    s_mul_i32 s42, s42, 144
    s_mul_i32 s43, s3, 36
    s_add_u32 s42, s42, s43
    s_lshl_b32 s56, s42, 1
    s_lshl_b32 s55, s42, 13
    s_lshr_b32 s43, s63, 2
    s_lshl_b32 s43, s43, 8
    s_add_u32 s55, s55, s43
    s_and_b32 s44, s2, 7
    s_lshl_b32 s44, s44, 7
    s_lshr_b32 s45, s2, 7
    s_lshl_b32 s45, s45, 6
    s_add_u32 s44, s44, s45
    s_add_u32 s44, s44, 1540096
    v_lshlrev_b32 v82, 2, v2
    buffer_load_dword v83, v82, s[4:7], s44 offen sc1
    s_add_u32 s42, s57, 0
    s_and_b32 s42, s42, 7
    s_lshl_b32 s42, s42, 12
    s_add_u32 s43, s47, s42
    s_lshl_b32 s42, s3, 15
    s_add_u32 m0, s42, 0
    s_nop 0
    buffer_load_dwordx4 v200, s[16:19], s43 offen offset:0 nt lds
    buffer_load_dwordx4 v201, s[16:19], s43 offen offset:1024 nt lds
    buffer_load_dwordx4 v202, s[16:19], s43 offen offset:2048 nt lds
    buffer_load_dwordx4 v203, s[16:19], s43 offen offset:3072 nt lds
    s_add_u32 s42, s57, 1
    s_and_b32 s42, s42, 7
    s_lshl_b32 s42, s42, 12
    s_add_u32 s43, s47, s42
    s_lshl_b32 s42, s3, 15
    s_add_u32 m0, s42, 4096
    s_nop 0
    buffer_load_dwordx4 v200, s[16:19], s43 offen offset:0 nt lds
    buffer_load_dwordx4 v201, s[16:19], s43 offen offset:1024 nt lds
    buffer_load_dwordx4 v202, s[16:19], s43 offen offset:2048 nt lds
    buffer_load_dwordx4 v203, s[16:19], s43 offen offset:3072 nt lds
    s_add_u32 s42, s57, 2
    s_and_b32 s42, s42, 7
    s_lshl_b32 s42, s42, 12
    s_add_u32 s43, s47, s42
    s_lshl_b32 s42, s3, 15
    s_add_u32 m0, s42, 8192
    s_nop 0
    buffer_load_dwordx4 v200, s[16:19], s43 offen offset:0 nt lds
    buffer_load_dwordx4 v201, s[16:19], s43 offen offset:1024 nt lds
    buffer_load_dwordx4 v202, s[16:19], s43 offen offset:2048 nt lds
    buffer_load_dwordx4 v203, s[16:19], s43 offen offset:3072 nt lds
    s_waitcnt vmcnt(12)
    s_add_u32 s42, s57, 3
    s_and_b32 s42, s42, 7
    s_lshl_b32 s42, s42, 12
    s_add_u32 s43, s47, s42
    s_lshl_b32 s42, s3, 15
    s_add_u32 m0, s42, 12288
    s_nop 0
    buffer_load_dwordx4 v200, s[16:19], s43 offen offset:0 nt lds
    buffer_load_dwordx4 v201, s[16:19], s43 offen offset:1024 nt lds
    buffer_load_dwordx4 v202, s[16:19], s43 offen offset:2048 nt lds
    buffer_load_dwordx4 v203, s[16:19], s43 offen offset:3072 nt lds
    buffer_load_ushort v22, v20, s[8:11], s56 offen offset:0
    buffer_load_ushort v23, v20, s[8:11], s56 offen offset:2
    buffer_load_ushort v24, v20, s[8:11], s56 offen offset:4
    buffer_load_ushort v25, v20, s[8:11], s56 offen offset:6
    buffer_load_ushort v26, v20, s[8:11], s56 offen offset:8
    buffer_load_ushort v27, v20, s[8:11], s56 offen offset:10
    buffer_load_ushort v28, v20, s[8:11], s56 offen offset:12
    buffer_load_ushort v29, v20, s[8:11], s56 offen offset:14
    buffer_load_ushort v30, v20, s[8:11], s56 offen offset:16
    s_add_u32 s44, s55, 0
    buffer_load_dwordx4 v[32:35], v21, s[12:15], s44 offen nt
    s_add_u32 s44, s55, 8192
    buffer_load_dwordx4 v[36:39], v21, s[12:15], s44 offen nt
    s_add_u32 s44, s55, 16384
    buffer_load_dwordx4 v[40:43], v21, s[12:15], s44 offen nt
    s_add_u32 s44, s55, 24576
    buffer_load_dwordx4 v[44:47], v21, s[12:15], s44 offen nt
    s_add_u32 s44, s55, 32768
    buffer_load_dwordx4 v[48:51], v21, s[12:15], s44 offen nt
    s_add_u32 s44, s55, 40960
    buffer_load_dwordx4 v[52:55], v21, s[12:15], s44 offen nt
    s_add_u32 s44, s55, 49152
    buffer_load_dwordx4 v[56:59], v21, s[12:15], s44 offen nt
    s_add_u32 s44, s55, 57344
    buffer_load_dwordx4 v[60:63], v21, s[12:15], s44 offen nt
    s_add_u32 s44, s55, 65536
    buffer_load_dwordx4 v[64:67], v21, s[12:15], s44 offen nt
    s_add_u32 s42, s57, 4
    s_and_b32 s42, s42, 7
    s_lshl_b32 s42, s42, 12
    s_add_u32 s43, s47, s42
    s_lshl_b32 s42, s3, 15
    s_add_u32 m0, s42, 16384
    s_nop 0
    buffer_load_dwordx4 v200, s[16:19], s43 offen offset:0 nt lds
    buffer_load_dwordx4 v201, s[16:19], s43 offen offset:1024 nt lds
    buffer_load_dwordx4 v202, s[16:19], s43 offen offset:2048 nt lds
    buffer_load_dwordx4 v203, s[16:19], s43 offen offset:3072 nt lds
    s_add_u32 s42, s57, 5
    s_and_b32 s42, s42, 7
    s_lshl_b32 s42, s42, 12
    s_add_u32 s43, s47, s42
    s_lshl_b32 s42, s3, 15
    s_add_u32 m0, s42, 20480
    s_nop 0
    buffer_load_dwordx4 v200, s[16:19], s43 offen offset:0 nt lds
    buffer_load_dwordx4 v201, s[16:19], s43 offen offset:1024 nt lds
    buffer_load_dwordx4 v202, s[16:19], s43 offen offset:2048 nt lds
    buffer_load_dwordx4 v203, s[16:19], s43 offen offset:3072 nt lds
    v_cmp_ne_u32 vcc, v12, v83
    s_mov_b32 s65, 16777216
    s_nop 0
    s_cmp_eq_u64 vcc, 0
    s_cselect_b32 s65, s65, 0
    s_waitcnt vmcnt(17)
    v_perm_b32 v72, v22, v22, v4
    v_perm_b32 v73, v22, v22, v5
    v_perm_b32 v74, v22, v22, v6
    v_perm_b32 v75, v22, v22, v7
    v_perm_b32 v76, v23, v23, v4
    v_perm_b32 v77, v23, v23, v5
    v_perm_b32 v78, v23, v23, v6
    v_perm_b32 v79, v23, v23, v7
    s_waitcnt vmcnt(16)
    v_mfma_f32_16x16x32_bf16 v[68:71], v[32:35], v[72:75], 0
    v_perm_b32 v72, v24, v24, v4
    v_perm_b32 v73, v24, v24, v5
    v_perm_b32 v74, v24, v24, v6
    v_perm_b32 v75, v24, v24, v7
    s_waitcnt vmcnt(15)
    v_mfma_f32_16x16x32_bf16 v[68:71], v[36:39], v[76:79], v[68:71]
    v_perm_b32 v76, v25, v25, v4
    v_perm_b32 v77, v25, v25, v5
    v_perm_b32 v78, v25, v25, v6
    v_perm_b32 v79, v25, v25, v7
    s_waitcnt vmcnt(14)
    v_mfma_f32_16x16x32_bf16 v[68:71], v[40:43], v[72:75], v[68:71]
    v_perm_b32 v72, v26, v26, v4
    v_perm_b32 v73, v26, v26, v5
    v_perm_b32 v74, v26, v26, v6
    v_perm_b32 v75, v26, v26, v7
    s_waitcnt vmcnt(13)
    v_mfma_f32_16x16x32_bf16 v[68:71], v[44:47], v[76:79], v[68:71]
    v_perm_b32 v76, v27, v27, v4
    v_perm_b32 v77, v27, v27, v5
    v_perm_b32 v78, v27, v27, v6
    v_perm_b32 v79, v27, v27, v7
    s_waitcnt vmcnt(12)
    v_mfma_f32_16x16x32_bf16 v[68:71], v[48:51], v[72:75], v[68:71]
    v_perm_b32 v72, v28, v28, v4
    v_perm_b32 v73, v28, v28, v5
    v_perm_b32 v74, v28, v28, v6
    v_perm_b32 v75, v28, v28, v7
    s_waitcnt vmcnt(11)
    v_mfma_f32_16x16x32_bf16 v[68:71], v[52:55], v[76:79], v[68:71]
    v_perm_b32 v76, v29, v29, v4
    v_perm_b32 v77, v29, v29, v5
    v_perm_b32 v78, v29, v29, v6
    v_perm_b32 v79, v29, v29, v7
    s_waitcnt vmcnt(10)
    v_mfma_f32_16x16x32_bf16 v[68:71], v[56:59], v[72:75], v[68:71]
    v_perm_b32 v72, v30, v30, v4
    v_perm_b32 v73, v30, v30, v5
    v_perm_b32 v74, v30, v30, v6
    v_perm_b32 v75, v30, v30, v7
    s_waitcnt vmcnt(9)
    v_mfma_f32_16x16x32_bf16 v[68:71], v[60:63], v[76:79], v[68:71]
    s_waitcnt vmcnt(8)
    v_mfma_f32_16x16x32_bf16 v[68:71], v[64:67], v[72:75], v[68:71]
    s_nop 7
    ds_write_b32 v14, v68 offset:0
    ds_write_b32 v14, v69 offset:32
    ds_write_b32 v14, v70 offset:64
    ds_write_b32 v14, v71 offset:96
    v_mov_b32 v81, v12
    s_lshl_b32 s42, s63, 11
    s_add_u32 s42, s42, 4096
    s_add_u32 s43, s42, 16777216
    s_waitcnt lgkmcnt(0)
    s_barrier
    ds_read_b32 v72, v15 offset:0
    ds_read_b32 v73, v15 offset:1024
    ds_read_b32 v74, v15 offset:2048
    ds_read_b32 v75, v15 offset:3072
    s_waitcnt lgkmcnt(0)
    v_add_f32 v72, v72, v73
    v_add_f32 v74, v74, v75
    v_add_f32 v80, v72, v74
    buffer_store_dwordx2 v[80:81], v16, s[4:7], s43 offen
    buffer_store_dwordx2 v[80:81], v16, s[4:7], s42 offen sc1
    s_add_u32 s42, s57, 6
    s_and_b32 s42, s42, 7
    s_lshl_b32 s42, s42, 12
    s_add_u32 s43, s47, s42
    s_lshl_b32 s42, s3, 15
    s_add_u32 m0, s42, 24576
    s_nop 0
    buffer_load_dwordx4 v200, s[16:19], s43 offen offset:0 nt lds
    buffer_load_dwordx4 v201, s[16:19], s43 offen offset:1024 nt lds
    buffer_load_dwordx4 v202, s[16:19], s43 offen offset:2048 nt lds
    buffer_load_dwordx4 v203, s[16:19], s43 offen offset:3072 nt lds
    s_waitcnt vmcnt(12)
    s_add_u32 s42, s57, 7
    s_and_b32 s42, s42, 7
    s_lshl_b32 s42, s42, 12
    s_add_u32 s43, s47, s42
    s_lshl_b32 s42, s3, 15
    s_add_u32 m0, s42, 28672
    s_nop 0
    buffer_load_dwordx4 v200, s[16:19], s43 offen offset:0 nt lds
    buffer_load_dwordx4 v201, s[16:19], s43 offen offset:1024 nt lds
    buffer_load_dwordx4 v202, s[16:19], s43 offen offset:2048 nt lds
    buffer_load_dwordx4 v203, s[16:19], s43 offen offset:3072 nt lds
    s_bfe_u32 s42, s62, 0x40002
    s_lshl_b32 s42, s42, 1
    s_lshr_b32 s43, s3, 1
    s_add_u32 s42, s42, s43
    s_lshl_b32 s50, s42, 13
    s_lshr_b32 s42, s62, 6
    s_lshl_b32 s42, s42, 10
    s_add_u32 s50, s50, s42
    s_and_b32 s42, s3, 1
    s_lshl_b32 s42, s42, 9
    s_add_u32 s50, s50, s42
    s_add_u32 s0, s50, 4096
    s_add_u32 s50, s0, s65
    s_add_u32 s45, s50, 4096
    buffer_load_dwordx2 v[86:87], v85, s[4:7], s50 offen sc1
    buffer_load_dwordx2 v[88:89], v85, s[4:7], s50 offen offset:2048 sc1
    buffer_load_dwordx2 v[90:91], v85, s[4:7], s45 offen sc1
    buffer_load_dwordx2 v[92:93], v85, s[4:7], s45 offen offset:2048 sc1
    s_add_u32 s51, s57, 0
    s_and_b32 s51, s51, 7
    s_lshl_b32 s51, s51, 12
    s_add_u32 s51, s47, s51
    buffer_load_dwordx4 a[0:3], v204, s[20:23], s51 offen offset:0 nt
    buffer_load_dwordx4 a[4:7], v204, s[20:23], s51 offen offset:256 nt
    buffer_load_dwordx4 a[8:11], v204, s[20:23], s51 offen offset:512 nt
    buffer_load_dwordx4 a[12:15], v204, s[20:23], s51 offen offset:768 nt
    s_add_u32 s51, s57, 1
    s_and_b32 s51, s51, 7
    s_lshl_b32 s51, s51, 12
    s_add_u32 s51, s47, s51
    buffer_load_dwordx4 a[16:19], v204, s[20:23], s51 offen offset:0 nt
    buffer_load_dwordx4 a[20:23], v204, s[20:23], s51 offen offset:256 nt
    buffer_load_dwordx4 a[24:27], v204, s[20:23], s51 offen offset:512 nt
    buffer_load_dwordx4 a[28:31], v204, s[20:23], s51 offen offset:768 nt
    s_add_u32 s51, s57, 2
    s_and_b32 s51, s51, 7
    s_lshl_b32 s51, s51, 12
    s_add_u32 s51, s47, s51
    buffer_load_dwordx4 a[32:35], v204, s[20:23], s51 offen offset:0 nt
    buffer_load_dwordx4 a[36:39], v204, s[20:23], s51 offen offset:256 nt
    buffer_load_dwordx4 a[40:43], v204, s[20:23], s51 offen offset:512 nt
    buffer_load_dwordx4 a[44:47], v204, s[20:23], s51 offen offset:768 nt
    s_add_u32 s51, s57, 3
    s_and_b32 s51, s51, 7
    s_lshl_b32 s51, s51, 12
    s_add_u32 s51, s47, s51
    buffer_load_dwordx4 a[48:51], v204, s[20:23], s51 offen offset:0 nt
    buffer_load_dwordx4 a[52:55], v204, s[20:23], s51 offen offset:256 nt
    buffer_load_dwordx4 a[56:59], v204, s[20:23], s51 offen offset:512 nt
    buffer_load_dwordx4 a[60:63], v204, s[20:23], s51 offen offset:768 nt
    s_waitcnt vmcnt(16)
    s_mov_b32 s48, 3000000
L_chk_5:
    s_mov_b64 s[32:33], exec
    v_cmpx_eq_u32 vcc, v12, v87
    v_cmpx_eq_u32 vcc, v12, v89
    v_cmpx_eq_u32 vcc, v12, v91
    v_cmpx_eq_u32 vcc, v12, v93
    s_nop 3
    s_cmp_eq_u64 exec, s[32:33]
    s_mov_b64 exec, s[32:33]
    s_cbranch_scc1 L_ok_6
    s_sub_u32 s48, s48, 1
    s_cmp_eq_u32 s48, 0
    s_cbranch_scc1 L_to_7
    s_cmp_eq_u32 s48, 2999744
    s_cbranch_scc0 L_nf_8
    s_mov_b32 s65, 0
    s_mov_b32 s50, s0
L_nf_8:
    s_add_u32 s45, s50, 4096
    buffer_load_dwordx2 v[86:87], v85, s[4:7], s50 offen sc1
    buffer_load_dwordx2 v[88:89], v85, s[4:7], s50 offen offset:2048 sc1
    buffer_load_dwordx2 v[90:91], v85, s[4:7], s45 offen sc1
    buffer_load_dwordx2 v[92:93], v85, s[4:7], s45 offen offset:2048 sc1
    s_waitcnt vmcnt(0)
    s_branch L_chk_5
L_to_7:
    s_mov_b32 s32, s60
    s_mov_b32 s33, s61
    s_mov_b32 s34, 256
    s_mov_b32 s35, 0x20000
    v_mov_b32 v17, 0
    v_mov_b32 v18, 1
    buffer_store_dword v18, v17, s[32:35], 0 offen
    s_waitcnt vmcnt(0)
L_ok_6:
    v_add_f32 v86, v86, v88
    v_add_f32 v90, v90, v92
    v_lshlrev_b32 v17, 1, v0
    v_add_f32 v86, v86, v90
    v_add_u32 v17, 131072, v17
    v_cvt_pk_bf16_f32 v86, v86, v86
    ds_write_b16 v17, v86 offset:4096
    v_lshlrev_b32 v17, 8, v13
    v_lshl_add_u32 v17, v3, 4, v17
    v_add_u32 v17, 131072, v17
    s_waitcnt lgkmcnt(0)
    s_barrier
    ds_read_b128 v[96:99], v17 offset:4096
    ds_read_b128 v[100:103], v17 offset:4160
    ds_read_b128 v[104:107], v17 offset:4224
    ds_read_b128 v[108:111], v17 offset:4288
    ds_read_b128 v[116:119], v112 offset:0
    ds_read_b128 v[120:123], v113 offset:0
    ds_read_b128 v[124:127], v114 offset:0
    ds_read_b128 v[128:131], v115 offset:0
    ds_read_b128 v[132:135], v112 offset:4096
    ds_read_b128 v[136:139], v113 offset:4096
    ds_read_b128 v[140:143], v114 offset:4096
    ds_read_b128 v[144:147], v115 offset:4096
    s_waitcnt lgkmcnt(7)
    v_mfma_f32_16x16x32_bf16 v[148:151], v[116:119], v[96:99], 0
    ds_read_b128 v[116:119], v112 offset:8192
    s_add_u32 s51, s57, 4
    s_and_b32 s51, s51, 7
    s_lshl_b32 s51, s51, 12
    s_add_u32 s51, s47, s51
    buffer_load_dwordx4 a[64:67], v204, s[20:23], s51 offen offset:0 nt
    s_waitcnt lgkmcnt(7)
    v_mfma_f32_16x16x32_bf16 v[148:151], v[120:123], v[100:103], v[148:151]
    ds_read_b128 v[120:123], v113 offset:8192
    s_waitcnt lgkmcnt(7)
    v_mfma_f32_16x16x32_bf16 v[148:151], v[124:127], v[104:107], v[148:151]
    ds_read_b128 v[124:127], v114 offset:8192
    buffer_load_dwordx4 a[68:71], v204, s[20:23], s51 offen offset:256 nt
    s_waitcnt lgkmcnt(7)
    v_mfma_f32_16x16x32_bf16 v[148:151], v[128:131], v[108:111], v[148:151]
    ds_read_b128 v[128:131], v115 offset:8192
    s_waitcnt lgkmcnt(7)
    v_mfma_f32_16x16x32_bf16 v[152:155], v[132:135], v[96:99], 0
    ds_read_b128 v[132:135], v112 offset:12288
    buffer_load_dwordx4 a[72:75], v204, s[20:23], s51 offen offset:512 nt
    s_waitcnt lgkmcnt(7)
    v_mfma_f32_16x16x32_bf16 v[152:155], v[136:139], v[100:103], v[152:155]
    ds_read_b128 v[136:139], v113 offset:12288
    s_waitcnt lgkmcnt(7)
    v_mfma_f32_16x16x32_bf16 v[152:155], v[140:143], v[104:107], v[152:155]
    ds_read_b128 v[140:143], v114 offset:12288
    buffer_load_dwordx4 a[76:79], v204, s[20:23], s51 offen offset:768 nt
    s_waitcnt lgkmcnt(7)
    v_mfma_f32_16x16x32_bf16 v[152:155], v[144:147], v[108:111], v[152:155]
    ds_read_b128 v[144:147], v115 offset:12288
    s_waitcnt lgkmcnt(7)
    v_mfma_f32_16x16x32_bf16 v[156:159], v[116:119], v[96:99], 0
    ds_read_b128 v[116:119], v112 offset:16384
    s_add_u32 s51, s57, 5
    s_and_b32 s51, s51, 7
    s_lshl_b32 s51, s51, 12
    s_add_u32 s51, s47, s51
    buffer_load_dwordx4 a[80:83], v204, s[20:23], s51 offen offset:0 nt
    s_waitcnt lgkmcnt(7)
    v_mfma_f32_16x16x32_bf16 v[156:159], v[120:123], v[100:103], v[156:159]
    ds_read_b128 v[120:123], v113 offset:16384
    s_waitcnt lgkmcnt(7)
    v_mfma_f32_16x16x32_bf16 v[156:159], v[124:127], v[104:107], v[156:159]
    ds_read_b128 v[124:127], v114 offset:16384
    buffer_load_dwordx4 a[84:87], v204, s[20:23], s51 offen offset:256 nt
    s_waitcnt lgkmcnt(7)
    v_mfma_f32_16x16x32_bf16 v[156:159], v[128:131], v[108:111], v[156:159]
    ds_read_b128 v[128:131], v115 offset:16384
    s_waitcnt lgkmcnt(7)
    v_mfma_f32_16x16x32_bf16 v[160:163], v[132:135], v[96:99], 0
    ds_read_b128 v[132:135], v112 offset:20480
    buffer_load_dwordx4 a[88:91], v204, s[20:23], s51 offen offset:512 nt
    s_waitcnt lgkmcnt(7)
    v_mfma_f32_16x16x32_bf16 v[160:163], v[136:139], v[100:103], v[160:163]
    ds_read_b128 v[136:139], v113 offset:20480
    s_waitcnt lgkmcnt(7)
    v_mfma_f32_16x16x32_bf16 v[160:163], v[140:143], v[104:107], v[160:163]
    ds_read_b128 v[140:143], v114 offset:20480
    buffer_load_dwordx4 a[92:95], v204, s[20:23], s51 offen offset:768 nt
    s_waitcnt lgkmcnt(7)
    v_mfma_f32_16x16x32_bf16 v[160:163], v[144:147], v[108:111], v[160:163]
    ds_read_b128 v[144:147], v115 offset:20480
    s_waitcnt lgkmcnt(7)
    v_mfma_f32_16x16x32_bf16 v[164:167], v[116:119], v[96:99], 0
    ds_read_b128 v[116:119], v112 offset:24576
    s_add_u32 s51, s57, 6
    s_and_b32 s51, s51, 7
    s_lshl_b32 s51, s51, 12
    s_add_u32 s51, s47, s51
    buffer_load_dwordx4 a[96:99], v204, s[20:23], s51 offen offset:0 nt
    s_waitcnt lgkmcnt(7)
    v_mfma_f32_16x16x32_bf16 v[164:167], v[120:123], v[100:103], v[164:167]
    ds_read_b128 v[120:123], v113 offset:24576
    s_waitcnt lgkmcnt(7)
    v_mfma_f32_16x16x32_bf16 v[164:167], v[124:127], v[104:107], v[164:167]
    ds_read_b128 v[124:127], v114 offset:24576
    buffer_load_dwordx4 a[100:103], v204, s[20:23], s51 offen offset:256 nt
    s_waitcnt lgkmcnt(7)
    v_mfma_f32_16x16x32_bf16 v[164:167], v[128:131], v[108:111], v[164:167]
    ds_read_b128 v[128:131], v115 offset:24576
    s_waitcnt lgkmcnt(7)
    v_mfma_f32_16x16x32_bf16 v[168:171], v[132:135], v[96:99], 0
    ds_read_b128 v[132:135], v112 offset:28672
    buffer_load_dwordx4 a[104:107], v204, s[20:23], s51 offen offset:512 nt
    s_waitcnt lgkmcnt(7)
    v_mfma_f32_16x16x32_bf16 v[168:171], v[136:139], v[100:103], v[168:171]
    ds_read_b128 v[136:139], v113 offset:28672
    s_waitcnt lgkmcnt(7)
    v_mfma_f32_16x16x32_bf16 v[168:171], v[140:143], v[104:107], v[168:171]
    ds_read_b128 v[140:143], v114 offset:28672
    buffer_load_dwordx4 a[108:111], v204, s[20:23], s51 offen offset:768 nt
    s_waitcnt lgkmcnt(7)
    v_mfma_f32_16x16x32_bf16 v[168:171], v[144:147], v[108:111], v[168:171]
    ds_read_b128 v[144:147], v115 offset:28672
    s_waitcnt lgkmcnt(7)
    v_mfma_f32_16x16x32_bf16 v[172:175], v[116:119], v[96:99], 0
    s_add_u32 s51, s57, 7
    s_and_b32 s51, s51, 7
    s_lshl_b32 s51, s51, 12
    s_add_u32 s51, s47, s51
    buffer_load_dwordx4 a[112:115], v204, s[20:23], s51 offen offset:0 nt
    s_waitcnt lgkmcnt(6)
    v_mfma_f32_16x16x32_bf16 v[172:175], v[120:123], v[100:103], v[172:175]
    s_waitcnt lgkmcnt(5)
    v_mfma_f32_16x16x32_bf16 v[172:175], v[124:127], v[104:107], v[172:175]
    buffer_load_dwordx4 a[116:119], v204, s[20:23], s51 offen offset:256 nt
    s_waitcnt lgkmcnt(4)
    v_mfma_f32_16x16x32_bf16 v[172:175], v[128:131], v[108:111], v[172:175]
    s_waitcnt lgkmcnt(3)
    v_mfma_f32_16x16x32_bf16 v[176:179], v[132:135], v[96:99], 0
    buffer_load_dwordx4 a[120:123], v204, s[20:23], s51 offen offset:512 nt
    s_waitcnt lgkmcnt(2)
    v_mfma_f32_16x16x32_bf16 v[176:179], v[136:139], v[100:103], v[176:179]
    s_waitcnt lgkmcnt(1)
    v_mfma_f32_16x16x32_bf16 v[176:179], v[140:143], v[104:107], v[176:179]
    buffer_load_dwordx4 a[124:127], v204, s[20:23], s51 offen offset:768 nt
    s_waitcnt lgkmcnt(0)
    v_mfma_f32_16x16x32_bf16 v[176:179], v[144:147], v[108:111], v[176:179]
    v_max3_f32 v196, v148, v149, v150
    v_max3_f32 v196, v196, v151, v152
    v_max3_f32 v196, v196, v153, v154
    v_max3_f32 v196, v196, v155, v156
    v_max3_f32 v196, v196, v157, v158
    v_max3_f32 v196, v196, v159, v160
    v_max3_f32 v196, v196, v161, v162
    v_max3_f32 v196, v196, v163, v164
    v_max3_f32 v196, v196, v165, v166
    v_max3_f32 v196, v196, v167, v168
    v_max3_f32 v196, v196, v169, v170
    v_max3_f32 v196, v196, v171, v172
    v_max3_f32 v196, v196, v173, v174
    v_max3_f32 v196, v196, v175, v176
    v_max3_f32 v196, v196, v177, v178
    v_max_f32 v196, v196, v179
    v_mov_b32 v17, v196
    s_nop 1
    v_permlane16_swap_b32 v196, v17
    v_max_f32 v196, v196, v17
    v_mov_b32 v17, v196
    s_nop 1
    v_permlane32_swap_b32 v196, v17
    v_max_f32 v196, v196, v17
    v_mul_f32 v196, s58, v196
    v_fma_f32 v148, v148, s58, -v196
    v_fma_f32 v149, v149, s58, -v196
    v_fma_f32 v150, v150, s58, -v196
    v_fma_f32 v151, v151, s58, -v196
    v_fma_f32 v152, v152, s58, -v196
    v_fma_f32 v153, v153, s58, -v196
    v_fma_f32 v154, v154, s58, -v196
    v_fma_f32 v155, v155, s58, -v196
    v_fma_f32 v156, v156, s58, -v196
    v_fma_f32 v157, v157, s58, -v196
    v_fma_f32 v158, v158, s58, -v196
    v_fma_f32 v159, v159, s58, -v196
    v_fma_f32 v160, v160, s58, -v196
    v_fma_f32 v161, v161, s58, -v196
    v_fma_f32 v162, v162, s58, -v196
    v_fma_f32 v163, v163, s58, -v196
    v_fma_f32 v164, v164, s58, -v196
    v_fma_f32 v165, v165, s58, -v196
    v_fma_f32 v166, v166, s58, -v196
    v_fma_f32 v167, v167, s58, -v196
    v_fma_f32 v168, v168, s58, -v196
    v_fma_f32 v169, v169, s58, -v196
    v_fma_f32 v170, v170, s58, -v196
    v_fma_f32 v171, v171, s58, -v196
    v_fma_f32 v172, v172, s58, -v196
    v_fma_f32 v173, v173, s58, -v196
    v_fma_f32 v174, v174, s58, -v196
    v_fma_f32 v175, v175, s58, -v196
    v_fma_f32 v176, v176, s58, -v196
    v_fma_f32 v177, v177, s58, -v196
    v_fma_f32 v178, v178, s58, -v196
    v_fma_f32 v179, v179, s58, -v196
    v_exp_f32 v148, v148
    v_exp_f32 v149, v149
    v_exp_f32 v150, v150
    v_exp_f32 v151, v151
    v_exp_f32 v152, v152
    v_exp_f32 v153, v153
    v_exp_f32 v154, v154
    v_exp_f32 v155, v155
    v_exp_f32 v156, v156
    v_exp_f32 v157, v157
    v_exp_f32 v158, v158
    v_exp_f32 v159, v159
    v_exp_f32 v160, v160
    v_exp_f32 v161, v161
    v_exp_f32 v162, v162
    v_exp_f32 v163, v163
    v_exp_f32 v164, v164
    v_exp_f32 v165, v165
    v_exp_f32 v166, v166
    v_exp_f32 v167, v167
    v_exp_f32 v168, v168
    v_exp_f32 v169, v169
    v_exp_f32 v170, v170
    v_exp_f32 v171, v171
    v_exp_f32 v172, v172
    v_exp_f32 v173, v173
    v_exp_f32 v174, v174
    v_exp_f32 v175, v175
    v_exp_f32 v176, v176
    v_exp_f32 v177, v177
    v_exp_f32 v178, v178
    v_exp_f32 v179, v179
    v_add_f32 v197, v148, v149
    v_add_f32 v197, v197, v150
    v_add_f32 v197, v197, v151
    v_add_f32 v197, v197, v152
    v_add_f32 v197, v197, v153
    v_add_f32 v197, v197, v154
    v_add_f32 v197, v197, v155
    v_add_f32 v197, v197, v156
    v_add_f32 v197, v197, v157
    v_add_f32 v197, v197, v158
    v_add_f32 v197, v197, v159
    v_add_f32 v197, v197, v160
    v_add_f32 v197, v197, v161
    v_add_f32 v197, v197, v162
    v_add_f32 v197, v197, v163
    v_add_f32 v197, v197, v164
    v_add_f32 v197, v197, v165
    v_add_f32 v197, v197, v166
    v_add_f32 v197, v197, v167
    v_add_f32 v197, v197, v168
    v_add_f32 v197, v197, v169
    v_add_f32 v197, v197, v170
    v_add_f32 v197, v197, v171
    v_add_f32 v197, v197, v172
    v_add_f32 v197, v197, v173
    v_add_f32 v197, v197, v174
    v_add_f32 v197, v197, v175
    v_add_f32 v197, v197, v176
    v_add_f32 v197, v197, v177
    v_add_f32 v197, v197, v178
    v_add_f32 v197, v197, v179
    v_cvt_pk_bf16_f32 v180, v148, v149
    v_cvt_pk_bf16_f32 v181, v150, v151
    v_cvt_pk_bf16_f32 v182, v152, v153
    v_cvt_pk_bf16_f32 v183, v154, v155
    v_cvt_pk_bf16_f32 v184, v156, v157
    v_cvt_pk_bf16_f32 v185, v158, v159
    v_cvt_pk_bf16_f32 v186, v160, v161
    v_cvt_pk_bf16_f32 v187, v162, v163
    v_cvt_pk_bf16_f32 v188, v164, v165
    v_cvt_pk_bf16_f32 v189, v166, v167
    v_cvt_pk_bf16_f32 v190, v168, v169
    v_cvt_pk_bf16_f32 v191, v170, v171
    v_cvt_pk_bf16_f32 v192, v172, v173
    v_cvt_pk_bf16_f32 v193, v174, v175
    v_cvt_pk_bf16_f32 v194, v176, v177
    v_cvt_pk_bf16_f32 v195, v178, v179
    v_mov_b32 v17, v197
    s_nop 1
    v_permlane16_swap_b32 v197, v17
    v_add_f32 v197, v197, v17
    v_mov_b32 v17, v197
    s_nop 1
    v_permlane32_swap_b32 v197, v17
    v_add_f32 v197, v197, v17
    v_mul_u32_u24 v240, 9216, v3
    v_lshl_add_u32 v241, v2, 4, v240
    v_lshrrev_b32 v17, 3, v2
    v_mul_u32_u24 v17, 1152, v17
    v_and_b32 v18, 7, v2
    v_lshl_add_u32 v17, v18, 4, v17
    v_add_u32 v242, v240, v17
    v_add_u32 v242, 256, v242
    s_and_b32 s52, s63, 3
    s_lshr_b32 s50, s63, 2
    s_lshl_b32 s50, s50, 2
    s_add_u32 s50, s50, s3
    s_mul_i32 s50, s50, 36864
    s_mul_i32 s52, s52, 384
    s_add_u32 s50, s50, s52
    s_add_u32 s52, s50, 4608
    v_perm_b32 v72, v180, v180, v4
    v_perm_b32 v73, v180, v180, v5
    v_perm_b32 v74, v180, v180, v6
    v_perm_b32 v75, v180, v180, v7
    v_perm_b32 v76, v180, v180, v8
    v_perm_b32 v77, v180, v180, v9
    v_perm_b32 v78, v180, v180, v10
    v_perm_b32 v79, v180, v180, v11
    s_waitcnt vmcnt(31)
    v_mfma_f32_16x16x32_bf16 v[68:71], a[0:3], v[72:75], 0
    v_perm_b32 v72, v181, v181, v4
    v_perm_b32 v73, v181, v181, v5
    v_perm_b32 v74, v181, v181, v6
    v_perm_b32 v75, v181, v181, v7
    s_waitcnt vmcnt(30)
    v_mfma_f32_16x16x32_bf16 v[68:71], a[4:7], v[76:79], v[68:71]
    v_perm_b32 v76, v181, v181, v8
    v_perm_b32 v77, v181, v181, v9
    v_perm_b32 v78, v181, v181, v10
    v_perm_b32 v79, v181, v181, v11
    s_waitcnt vmcnt(29)
    v_mfma_f32_16x16x32_bf16 v[68:71], a[8:11], v[72:75], v[68:71]
    v_perm_b32 v72, v182, v182, v4
    v_perm_b32 v73, v182, v182, v5
    v_perm_b32 v74, v182, v182, v6
    v_perm_b32 v75, v182, v182, v7
    s_waitcnt vmcnt(28)
    v_mfma_f32_16x16x32_bf16 v[68:71], a[12:15], v[76:79], v[68:71]
    v_perm_b32 v76, v182, v182, v8
    v_perm_b32 v77, v182, v182, v9
    v_perm_b32 v78, v182, v182, v10
    v_perm_b32 v79, v182, v182, v11
    s_waitcnt vmcnt(27)
    v_mfma_f32_16x16x32_bf16 v[68:71], a[16:19], v[72:75], v[68:71]
    v_perm_b32 v72, v183, v183, v4
    v_perm_b32 v73, v183, v183, v5
    v_perm_b32 v74, v183, v183, v6
    v_perm_b32 v75, v183, v183, v7
    s_waitcnt vmcnt(26)
    v_mfma_f32_16x16x32_bf16 v[68:71], a[20:23], v[76:79], v[68:71]
    v_perm_b32 v76, v183, v183, v8
    v_perm_b32 v77, v183, v183, v9
    v_perm_b32 v78, v183, v183, v10
    v_perm_b32 v79, v183, v183, v11
    s_waitcnt vmcnt(25)
    v_mfma_f32_16x16x32_bf16 v[68:71], a[24:27], v[72:75], v[68:71]
    v_perm_b32 v72, v184, v184, v4
    v_perm_b32 v73, v184, v184, v5
    v_perm_b32 v74, v184, v184, v6
    v_perm_b32 v75, v184, v184, v7
    s_waitcnt vmcnt(24)
    v_mfma_f32_16x16x32_bf16 v[68:71], a[28:31], v[76:79], v[68:71]
    v_perm_b32 v76, v184, v184, v8
    v_perm_b32 v77, v184, v184, v9
    v_perm_b32 v78, v184, v184, v10
    v_perm_b32 v79, v184, v184, v11
    s_waitcnt vmcnt(23)
    v_mfma_f32_16x16x32_bf16 v[68:71], a[32:35], v[72:75], v[68:71]
    v_perm_b32 v72, v185, v185, v4
    v_perm_b32 v73, v185, v185, v5
    v_perm_b32 v74, v185, v185, v6
    v_perm_b32 v75, v185, v185, v7
    s_waitcnt vmcnt(22)
    v_mfma_f32_16x16x32_bf16 v[68:71], a[36:39], v[76:79], v[68:71]
    v_perm_b32 v76, v185, v185, v8
    v_perm_b32 v77, v185, v185, v9
    v_perm_b32 v78, v185, v185, v10
    v_perm_b32 v79, v185, v185, v11
    s_waitcnt vmcnt(21)
    v_mfma_f32_16x16x32_bf16 v[68:71], a[40:43], v[72:75], v[68:71]
    v_perm_b32 v72, v186, v186, v4
    v_perm_b32 v73, v186, v186, v5
    v_perm_b32 v74, v186, v186, v6
    v_perm_b32 v75, v186, v186, v7
    s_waitcnt vmcnt(20)
    v_mfma_f32_16x16x32_bf16 v[68:71], a[44:47], v[76:79], v[68:71]
    v_perm_b32 v76, v186, v186, v8
    v_perm_b32 v77, v186, v186, v9
    v_perm_b32 v78, v186, v186, v10
    v_perm_b32 v79, v186, v186, v11
    s_waitcnt vmcnt(19)
    v_mfma_f32_16x16x32_bf16 v[68:71], a[48:51], v[72:75], v[68:71]
    v_perm_b32 v72, v187, v187, v4
    v_perm_b32 v73, v187, v187, v5
    v_perm_b32 v74, v187, v187, v6
    v_perm_b32 v75, v187, v187, v7
    s_waitcnt vmcnt(18)
    v_mfma_f32_16x16x32_bf16 v[68:71], a[52:55], v[76:79], v[68:71]
    v_perm_b32 v76, v187, v187, v8
    v_perm_b32 v77, v187, v187, v9
    v_perm_b32 v78, v187, v187, v10
    v_perm_b32 v79, v187, v187, v11
    s_waitcnt vmcnt(17)
    v_mfma_f32_16x16x32_bf16 v[68:71], a[56:59], v[72:75], v[68:71]
    v_perm_b32 v72, v188, v188, v4
    v_perm_b32 v73, v188, v188, v5
    v_perm_b32 v74, v188, v188, v6
    v_perm_b32 v75, v188, v188, v7
    s_waitcnt vmcnt(16)
    v_mfma_f32_16x16x32_bf16 v[68:71], a[60:63], v[76:79], v[68:71]
    v_perm_b32 v76, v188, v188, v8
    v_perm_b32 v77, v188, v188, v9
    v_perm_b32 v78, v188, v188, v10
    v_perm_b32 v79, v188, v188, v11
    s_waitcnt vmcnt(15)
    v_mfma_f32_16x16x32_bf16 v[68:71], a[64:67], v[72:75], v[68:71]
    buffer_load_dwordx4 a[128:131], v241, s[24:27], s50 offen offset:0 nt
    v_perm_b32 v72, v189, v189, v4
    v_perm_b32 v73, v189, v189, v5
    v_perm_b32 v74, v189, v189, v6
    v_perm_b32 v75, v189, v189, v7
    s_waitcnt vmcnt(15)
    v_mfma_f32_16x16x32_bf16 v[68:71], a[68:71], v[76:79], v[68:71]
    buffer_load_dwordx4 a[132:135], v241, s[24:27], s50 offen offset:1152 nt
    v_perm_b32 v76, v189, v189, v8
    v_perm_b32 v77, v189, v189, v9
    v_perm_b32 v78, v189, v189, v10
    v_perm_b32 v79, v189, v189, v11
    s_waitcnt vmcnt(15)
    v_mfma_f32_16x16x32_bf16 v[68:71], a[72:75], v[72:75], v[68:71]
    buffer_load_dwordx4 a[136:139], v241, s[24:27], s50 offen offset:2304 nt
    v_perm_b32 v72, v190, v190, v4
    v_perm_b32 v73, v190, v190, v5
    v_perm_b32 v74, v190, v190, v6
    v_perm_b32 v75, v190, v190, v7
    s_waitcnt vmcnt(15)
    v_mfma_f32_16x16x32_bf16 v[68:71], a[76:79], v[76:79], v[68:71]
    buffer_load_dwordx4 a[140:143], v241, s[24:27], s50 offen offset:3456 nt
    v_perm_b32 v76, v190, v190, v8
    v_perm_b32 v77, v190, v190, v9
    v_perm_b32 v78, v190, v190, v10
    v_perm_b32 v79, v190, v190, v11
    s_waitcnt vmcnt(15)
    v_mfma_f32_16x16x32_bf16 v[68:71], a[80:83], v[72:75], v[68:71]
    buffer_load_dwordx4 a[144:147], v241, s[24:27], s52 offen offset:0 nt
    v_perm_b32 v72, v191, v191, v4
    v_perm_b32 v73, v191, v191, v5
    v_perm_b32 v74, v191, v191, v6
    v_perm_b32 v75, v191, v191, v7
    s_waitcnt vmcnt(15)
    v_mfma_f32_16x16x32_bf16 v[68:71], a[84:87], v[76:79], v[68:71]
    buffer_load_dwordx4 a[148:151], v241, s[24:27], s52 offen offset:1152 nt
    v_perm_b32 v76, v191, v191, v8
    v_perm_b32 v77, v191, v191, v9
    v_perm_b32 v78, v191, v191, v10
    v_perm_b32 v79, v191, v191, v11
    s_waitcnt vmcnt(15)
    v_mfma_f32_16x16x32_bf16 v[68:71], a[88:91], v[72:75], v[68:71]
    buffer_load_dwordx4 a[152:155], v241, s[24:27], s52 offen offset:2304 nt
    v_perm_b32 v72, v192, v192, v4
    v_perm_b32 v73, v192, v192, v5
    v_perm_b32 v74, v192, v192, v6
    v_perm_b32 v75, v192, v192, v7
    s_waitcnt vmcnt(15)
    v_mfma_f32_16x16x32_bf16 v[68:71], a[92:95], v[76:79], v[68:71]
    buffer_load_dwordx4 a[156:159], v241, s[24:27], s52 offen offset:3456 nt
    v_perm_b32 v76, v192, v192, v8
    v_perm_b32 v77, v192, v192, v9
    v_perm_b32 v78, v192, v192, v10
    v_perm_b32 v79, v192, v192, v11
    s_waitcnt vmcnt(15)
    v_mfma_f32_16x16x32_bf16 v[68:71], a[96:99], v[72:75], v[68:71]
    buffer_load_dwordx4 a[160:163], v242, s[24:27], s50 offen offset:0 nt
    v_perm_b32 v72, v193, v193, v4
    v_perm_b32 v73, v193, v193, v5
    v_perm_b32 v74, v193, v193, v6
    v_perm_b32 v75, v193, v193, v7
    s_waitcnt vmcnt(15)
    v_mfma_f32_16x16x32_bf16 v[68:71], a[100:103], v[76:79], v[68:71]
    buffer_load_dwordx4 a[164:167], v242, s[24:27], s50 offen offset:2304 nt
    v_perm_b32 v76, v193, v193, v8
    v_perm_b32 v77, v193, v193, v9
    v_perm_b32 v78, v193, v193, v10
    v_perm_b32 v79, v193, v193, v11
    s_waitcnt vmcnt(15)
    v_mfma_f32_16x16x32_bf16 v[68:71], a[104:107], v[72:75], v[68:71]
    buffer_load_dwordx4 a[168:171], v242, s[24:27], s52 offen offset:0 nt
    v_perm_b32 v72, v194, v194, v4
    v_perm_b32 v73, v194, v194, v5
    v_perm_b32 v74, v194, v194, v6
    v_perm_b32 v75, v194, v194, v7
    s_waitcnt vmcnt(15)
    v_mfma_f32_16x16x32_bf16 v[68:71], a[108:111], v[76:79], v[68:71]
    buffer_load_dwordx4 a[172:175], v242, s[24:27], s52 offen offset:2304 nt
    v_perm_b32 v76, v194, v194, v8
    v_perm_b32 v77, v194, v194, v9
    v_perm_b32 v78, v194, v194, v10
    v_perm_b32 v79, v194, v194, v11
    s_waitcnt vmcnt(15)
    v_mfma_f32_16x16x32_bf16 v[68:71], a[112:115], v[72:75], v[68:71]
    v_perm_b32 v72, v195, v195, v4
    v_perm_b32 v73, v195, v195, v5
    v_perm_b32 v74, v195, v195, v6
    v_perm_b32 v75, v195, v195, v7
    s_waitcnt vmcnt(14)
    v_mfma_f32_16x16x32_bf16 v[68:71], a[116:119], v[76:79], v[68:71]
    v_perm_b32 v76, v195, v195, v8
    v_perm_b32 v77, v195, v195, v9
    v_perm_b32 v78, v195, v195, v10
    v_perm_b32 v79, v195, v195, v11
    s_waitcnt vmcnt(13)
    v_mfma_f32_16x16x32_bf16 v[68:71], a[120:123], v[72:75], v[68:71]
    s_waitcnt vmcnt(12)
    v_mfma_f32_16x16x32_bf16 v[68:71], a[124:127], v[76:79], v[68:71]
    v_lshlrev_b32 v17, 3, v13
    s_lshl_b32 s42, s3, 4
    s_add_u32 s42, s42, 143360
    v_add_u32 v17, s42, v17
    v_and_b32 v18, 0x37, v1
    v_cmp_eq_u32 vcc, 0, v18
    s_nop 0
    s_and_saveexec_b64 s[32:33], vcc
    ds_write_b64 v17, v[196:197]
    s_mov_b64 exec, s[32:33]
    ds_write_b32 v14, v68 offset:8192
    ds_write_b32 v14, v69 offset:8224
    ds_write_b32 v14, v70 offset:8256
    ds_write_b32 v14, v71 offset:8288
    v_lshrrev_b32 v102, 7, v0
    v_and_b32 v103, 127, v0
    v_lshlrev_b32 v19, 13, v102
    v_lshl_add_u32 v19, v103, 3, v19
    v_lshlrev_b32 v104, 7, v102
    v_lshlrev_b32 v17, 3, v102
    v_add_u32 v17, 143360, v17
    s_bfe_u32 s42, s62, 0x40002
    s_lshl_b32 s43, s42, 14
    s_and_b32 s44, s62, 3
    s_lshl_b32 s45, s44, 11
    s_add_u32 s43, s43, s45
    s_lshr_b32 s45, s62, 6
    s_lshl_b32 s45, s45, 10
    s_add_u32 s43, s43, s45
    s_add_u32 s51, s43, 786432
    s_lshl_b32 s43, s42, 8
    s_lshr_b32 s45, s62, 6
    s_lshl_b32 s45, s45, 6
    s_add_u32 s43, s43, s45
    s_lshl_b32 s44, s44, 4
    s_add_u32 s43, s43, s44
    s_add_u32 s52, s43, 1310720
    v_mov_b32 v95, v12
    v_mov_b32 v99, v12
    v_mov_b32 v101, v12
    s_waitcnt lgkmcnt(0)
    s_barrier
    ds_read_b64 v[80:81], v17 offset:0
    ds_read_b64 v[82:83], v17 offset:16
    ds_read_b64 v[84:85], v17 offset:32
    ds_read_b64 v[86:87], v17 offset:48
    ds_read_b32 v88, v15 offset:8192
    ds_read_b32 v89, v15 offset:9216
    ds_read_b32 v90, v15 offset:10240
    ds_read_b32 v91, v15 offset:11264
    s_waitcnt lgkmcnt(0)
    v_max3_f32 v98, v80, v82, v84
    v_max_f32 v98, v98, v86
    v_sub_f32 v80, v80, v98
    v_sub_f32 v82, v82, v98
    v_sub_f32 v84, v84, v98
    v_sub_f32 v86, v86, v98
    v_exp_f32 v80, v80
    v_exp_f32 v82, v82
    v_exp_f32 v84, v84
    v_exp_f32 v86, v86
    v_mul_f32 v94, v80, v88
    v_mul_f32 v100, v80, v81
    v_fmac_f32 v94, v82, v89
    v_fmac_f32 v100, v82, v83
    v_fmac_f32 v94, v84, v90
    v_fmac_f32 v100, v84, v85
    v_fmac_f32 v94, v86, v91
    v_fmac_f32 v100, v86, v87
    s_add_u32 s42, s51, 16777216
    s_add_u32 s43, s52, 16777216
    buffer_store_dwordx2 v[94:95], v19, s[4:7], s42 offen
    v_cmp_eq_u32 vcc, 0, v103
    s_nop 0
    s_and_saveexec_b64 s[32:33], vcc
    s_cbranch_execz L_s_noml
    buffer_store_dwordx4 v[98:101], v104, s[4:7], s43 offen
    buffer_store_dwordx4 v[98:101], v104, s[4:7], s52 offen sc1
L_s_noml:
    s_mov_b64 exec, s[32:33]
    buffer_store_dwordx2 v[94:95], v19, s[4:7], s51 offen sc1
    s_mov_b64 exec, s[32:33]
    s_lshr_b32 s49, s63, 2
    s_lshr_b32 s53, s63, 2
    s_branch L_stage4
L_roleB:
    s_sub_u32 s47, s2, 128
    s_lshl_b32 s47, s47, 17
    s_lshl_b32 s42, s3, 15
    s_add_u32 s47, s47, s42
    s_mul_i32 s57, s2, 20
    s_mul_i32 s42, s3, 12
    s_add_u32 s57, s57, s42
    s_add_u32 s43, s57, 0
    s_and_b32 s43, s43, 31
    s_lshl_b32 s43, s43, 10
    s_add_u32 s99, s47, s43
    s_lshl_b32 s44, s3, 15
    s_add_u32 m0, s44, 0
    v_xor_b32 v202, 0, v31
    v_xor_b32 v203, 64, v31
    v_xor_b32 v204, 128, v31
    v_xor_b32 v205, 192, v31
    buffer_load_dwordx4 v202, s[16:19], s99 offen offset:0 nt lds
    v_and_b32 v17, 1, v1
    v_cmp_eq_u32 vcc, 1, v17
    v_mov_b32 v18, 0x0c0c0100
    v_mov_b32 v19, 0x01000c0c
    v_cndmask_b32 v68, v18, v19, vcc
    v_mov_b32 v18, 0x0c0c0302
    v_mov_b32 v19, 0x03020c0c
    v_cndmask_b32 v69, v18, v19, vcc
    v_bfe_u32 v17, v1, 1, 2
    v_mov_b32 v18, 0x0c0c0c0c
    v_cmp_eq_u32 vcc, 0, v17
    s_nop 1
    v_cndmask_b32 v4, v18, v68, vcc
    v_cndmask_b32 v8, v18, v69, vcc
    v_cmp_eq_u32 vcc, 1, v17
    s_nop 1
    v_cndmask_b32 v5, v18, v68, vcc
    v_cndmask_b32 v9, v18, v69, vcc
    v_cmp_eq_u32 vcc, 2, v17
    s_nop 1
    v_cndmask_b32 v6, v18, v68, vcc
    v_cndmask_b32 v10, v18, v69, vcc
    v_cmp_eq_u32 vcc, 3, v17
    s_nop 1
    v_cndmask_b32 v7, v18, v68, vcc
    v_cndmask_b32 v11, v18, v69, vcc
    v_lshlrev_b32 v15, 2, v0
    v_add_u32 v15, 131072, v15
    v_lshlrev_b32 v16, 3, v0
    v_lshlrev_b32 v14, 9, v13
    v_lshl_add_u32 v14, v3, 7, v14
    v_and_b32 v17, 7, v1
    v_lshl_add_u32 v14, v17, 2, v14
    s_lshl_b32 s42, s3, 10
    s_add_u32 s42, s42, 131072
    v_add_u32 v14, s42, v14
    v_lshlrev_b32 v85, 3, v1
    s_mov_b32 s58, 0x3e0293ee
    s_waitcnt lgkmcnt(0)
    s_mul_i32 s46, s64, 0x9E3779B1
    s_add_u32 s46, s46, 0x7F4A7C15
    v_mov_b32 v12, s46
    s_and_b32 s42, s2, 7
    s_lshl_b32 s42, s42, 7
    s_lshr_b32 s43, s2, 3
    s_lshl_b32 s43, s43, 2
    s_add_u32 s42, s42, s43
    s_add_u32 s42, s42, 1540096
    v_mov_b32 v17, 0
    v_cmp_eq_u32 vcc, 0, v0
    s_nop 0
    s_and_saveexec_b64 s[32:33], vcc
    s_cbranch_execz L_nohello_9
    buffer_store_dword v12, v17, s[4:7], s42 offen
L_nohello_9:
    s_mov_b64 exec, s[32:33]
    s_lshr_b32 s49, s63, 2
    s_bfe_u32 s42, s2, 0x10006
    s_lshl_b32 s50, s42, 16
    s_lshl_b32 s42, s3, 14
    s_add_u32 s50, s50, s42
    s_add_u32 s50, s50, 589824
    s_waitcnt vmcnt(0)
    buffer_load_dwordx4 v203, s[16:19], s99 offen offset:1024 nt lds
    s_waitcnt vmcnt(0)
    buffer_load_dwordx4 v204, s[16:19], s99 offen offset:2048 nt lds
    buffer_load_dwordx4 v205, s[16:19], s99 offen offset:3072 nt lds
    s_add_u32 s43, s57, 4
    s_and_b32 s43, s43, 31
    s_lshl_b32 s43, s43, 10
    s_add_u32 s99, s47, s43
    s_lshl_b32 s44, s3, 15
    s_add_u32 m0, s44, 4096
    v_xor_b32 v202, 16, v31
    v_xor_b32 v203, 80, v31
    v_xor_b32 v204, 144, v31
    v_xor_b32 v205, 208, v31
    buffer_load_dwordx4 v202, s[16:19], s99 offen offset:0 nt lds
    buffer_load_dwordx4 v203, s[16:19], s99 offen offset:1024 nt lds
    buffer_load_dwordx4 v204, s[16:19], s99 offen offset:2048 nt lds
    buffer_load_dwordx4 v205, s[16:19], s99 offen offset:3072 nt lds
    s_add_u32 s43, s57, 8
    s_and_b32 s43, s43, 31
    s_lshl_b32 s43, s43, 10
    s_add_u32 s99, s47, s43
    s_lshl_b32 s44, s3, 15
    s_add_u32 m0, s44, 8192
    v_xor_b32 v202, 32, v31
    v_xor_b32 v203, 96, v31
    v_xor_b32 v204, 160, v31
    v_xor_b32 v205, 224, v31
    buffer_load_dwordx4 v202, s[16:19], s99 offen offset:0 nt lds
    buffer_load_dwordx4 v203, s[16:19], s99 offen offset:1024 nt lds
    buffer_load_dwordx4 v204, s[16:19], s99 offen offset:2048 nt lds
    buffer_load_dwordx4 v205, s[16:19], s99 offen offset:3072 nt lds
    s_add_u32 s43, s57, 12
    s_and_b32 s43, s43, 31
    s_lshl_b32 s43, s43, 10
    s_add_u32 s99, s47, s43
    s_lshl_b32 s44, s3, 15
    s_add_u32 m0, s44, 12288
    v_xor_b32 v202, 48, v31
    v_xor_b32 v203, 112, v31
    v_xor_b32 v204, 176, v31
    v_xor_b32 v205, 240, v31
    buffer_load_dwordx4 v202, s[16:19], s99 offen offset:0 nt lds
    buffer_load_dwordx4 v203, s[16:19], s99 offen offset:1024 nt lds
    buffer_load_dwordx4 v204, s[16:19], s99 offen offset:2048 nt lds
    buffer_load_dwordx4 v205, s[16:19], s99 offen offset:3072 nt lds
    v_and_b32 v17, 3, v1
    v_lshlrev_b32 v17, 2, v17
    v_bfe_u32 v18, v1, 2, 2
    v_or_b32 v17, v17, v18
    v_lshrrev_b32 v18, 5, v1
    v_xor_b32 v17, v17, v18
    v_lshlrev_b32 v17, 4, v17
    v_and_b32 v18, 31, v1
    v_lshl_add_u32 v17, v18, 10, v17
    s_lshl_b32 s42, s3, 15
    v_add_u32 v112, s42, v17
    v_add_u32 v120, 131072, v17
    v_lshlrev_b32 v243, 2, v18
    v_add_u32 v243, 131072, v243
    v_xor_b32 v113, 32, v112
    v_xor_b32 v121, 32, v120
    v_xor_b32 v114, 64, v112
    v_xor_b32 v122, 64, v120
    v_xor_b32 v115, 96, v112
    v_xor_b32 v123, 96, v120
    v_xor_b32 v116, 128, v112
    v_xor_b32 v124, 128, v120
    v_xor_b32 v117, 160, v112
    v_xor_b32 v125, 160, v120
    v_xor_b32 v118, 192, v112
    v_xor_b32 v126, 192, v120
    v_xor_b32 v119, 224, v112
    v_xor_b32 v127, 224, v120
    v_bfe_u32 v64, v1, 2, 2
    v_lshrrev_b32 v65, 5, v1
    v_bfe_u32 v66, v1, 4, 1
    v_bfe_u32 v67, v1, 1, 1
    v_lshl_add_u32 v66, v66, 1, v67
    v_xor_b32 v66, v66, v65
    v_lshl_add_u32 v66, v64, 2, v66
    v_lshlrev_b32 v66, 4, v66
    v_and_b32 v67, 1, v1
    v_lshl_add_u32 v66, v67, 3, v66
    v_lshl_add_u32 v67, v65, 2, v64
    v_lshl_add_u32 v66, v67, 10, v66
    s_lshl_b32 s42, s3, 8
    v_add_u32 v66, s42, v66
    v_xor_b32 v244, 0, v66
    v_xor_b32 v245, 32, v244
    v_add_u32 v245, 8192, v245
    v_xor_b32 v246, 64, v66
    v_xor_b32 v247, 32, v246
    v_add_u32 v247, 8192, v247
    v_xor_b32 v248, 128, v66
    v_xor_b32 v249, 32, v248
    v_add_u32 v249, 8192, v249
    v_xor_b32 v250, 192, v66
    v_xor_b32 v251, 32, v250
    v_add_u32 v251, 8192, v251
    v_lshrrev_b32 v17, 1, v1
    v_lshlrev_b32 v17, 4, v17
    v_and_b32 v18, 1, v1
    v_lshl_add_u32 v17, v18, 3, v17
    s_lshl_b32 s42, s3, 1
    s_and_b32 s42, s42, 3
    s_lshl_b32 s42, s42, 4
    s_add_u32 s43, s42, 16
    v_xor_b32 v206, s42, v17
    v_xor_b32 v207, s43, v17
    s_lshl_b32 s42, s3, 13
    s_add_u32 s42, s42, 131072
    v_add_u32 v206, s42, v206
    v_add_u32 v207, s42, v207
    s_mov_b32 s48, 3000000
    s_mov_b32 s1, 0xffff
    s_waitcnt vmcnt(12)
    s_add_u32 s43, s57, 16
    s_and_b32 s43, s43, 31
    s_lshl_b32 s43, s43, 10
    s_add_u32 s99, s47, s43
    s_lshl_b32 s44, s3, 15
    s_add_u32 m0, s44, 16384
    v_xor_b32 v202, 0, v31
    v_xor_b32 v203, 64, v31
    v_xor_b32 v204, 128, v31
    v_xor_b32 v205, 192, v31
    buffer_load_dwordx4 v202, s[16:19], s99 offen offset:0 nt lds
    buffer_load_dwordx4 v203, s[16:19], s99 offen offset:1024 nt lds
    buffer_load_dwordx4 v204, s[16:19], s99 offen offset:2048 nt lds
    buffer_load_dwordx4 v205, s[16:19], s99 offen offset:3072 nt lds
    s_waitcnt vmcnt(12)
    s_add_u32 s43, s57, 20
    s_and_b32 s43, s43, 31
    s_lshl_b32 s43, s43, 10
    s_add_u32 s99, s47, s43
    s_lshl_b32 s44, s3, 15
    s_add_u32 m0, s44, 20480
    v_xor_b32 v202, 16, v31
    v_xor_b32 v203, 80, v31
    v_xor_b32 v204, 144, v31
    v_xor_b32 v205, 208, v31
    buffer_load_dwordx4 v202, s[16:19], s99 offen offset:0 nt lds
    buffer_load_dwordx4 v203, s[16:19], s99 offen offset:1024 nt lds
    buffer_load_dwordx4 v204, s[16:19], s99 offen offset:2048 nt lds
    buffer_load_dwordx4 v205, s[16:19], s99 offen offset:3072 nt lds
    s_waitcnt vmcnt(12)
    s_add_u32 s43, s57, 24
    s_and_b32 s43, s43, 31
    s_lshl_b32 s43, s43, 10
    s_add_u32 s99, s47, s43
    s_lshl_b32 s44, s3, 15
    s_add_u32 m0, s44, 24576
    v_xor_b32 v202, 32, v31
    v_xor_b32 v203, 96, v31
    v_xor_b32 v204, 160, v31
    v_xor_b32 v205, 224, v31
    buffer_load_dwordx4 v202, s[16:19], s99 offen offset:0 nt lds
    buffer_load_dwordx4 v203, s[16:19], s99 offen offset:1024 nt lds
    buffer_load_dwordx4 v204, s[16:19], s99 offen offset:2048 nt lds
    buffer_load_dwordx4 v205, s[16:19], s99 offen offset:3072 nt lds
    s_waitcnt vmcnt(12)
    s_add_u32 s43, s57, 28
    s_and_b32 s43, s43, 31
    s_lshl_b32 s43, s43, 10
    s_add_u32 s99, s47, s43
    s_lshl_b32 s44, s3, 15
    s_add_u32 m0, s44, 28672
    v_xor_b32 v202, 48, v31
    v_xor_b32 v203, 112, v31
    v_xor_b32 v204, 176, v31
    v_xor_b32 v205, 240, v31
    buffer_load_dwordx4 v202, s[16:19], s99 offen offset:0 nt lds
    buffer_load_dwordx4 v203, s[16:19], s99 offen offset:1024 nt lds
    buffer_load_dwordx4 v204, s[16:19], s99 offen offset:2048 nt lds
    buffer_load_dwordx4 v205, s[16:19], s99 offen offset:3072 nt lds
    s_and_b32 s44, s2, 7
    s_lshl_b32 s44, s44, 7
    s_lshr_b32 s45, s2, 7
    s_lshl_b32 s45, s45, 6
    s_add_u32 s44, s44, s45
    s_add_u32 s44, s44, 1540096
    v_lshlrev_b32 v82, 2, v2
    buffer_load_dword v83, v82, s[4:7], s44 offen sc1
    s_add_u32 s45, s50, 0
    buffer_load_dwordx4 v[128:131], v31, s[4:7], s45 offen
    s_add_u32 s45, s50, 1024
    buffer_load_dwordx4 v[132:135], v31, s[4:7], s45 offen
    s_add_u32 s45, s50, 2048
    buffer_load_dwordx4 v[136:139], v31, s[4:7], s45 offen
    s_add_u32 s45, s50, 3072
    buffer_load_dwordx4 v[140:143], v31, s[4:7], s45 offen
    s_add_u32 s45, s50, 4096
    buffer_load_dwordx4 v[144:147], v31, s[4:7], s45 offen
    s_add_u32 s45, s50, 5120
    buffer_load_dwordx4 v[148:151], v31, s[4:7], s45 offen
    s_add_u32 s45, s50, 6144
    buffer_load_dwordx4 v[152:155], v31, s[4:7], s45 offen
    s_add_u32 s45, s50, 7168
    buffer_load_dwordx4 v[156:159], v31, s[4:7], s45 offen
    s_add_u32 s45, s50, 8192
    buffer_load_dwordx4 v[160:163], v31, s[4:7], s45 offen
    s_add_u32 s45, s50, 9216
    buffer_load_dwordx4 v[164:167], v31, s[4:7], s45 offen
    s_add_u32 s45, s50, 10240
    buffer_load_dwordx4 v[168:171], v31, s[4:7], s45 offen
    s_add_u32 s45, s50, 11264
    buffer_load_dwordx4 v[172:175], v31, s[4:7], s45 offen
    s_add_u32 s45, s50, 12288
    buffer_load_dwordx4 v[176:179], v31, s[4:7], s45 offen
    s_add_u32 s45, s50, 13312
    buffer_load_dwordx4 v[180:183], v31, s[4:7], s45 offen
    s_add_u32 s45, s50, 14336
    buffer_load_dwordx4 v[184:187], v31, s[4:7], s45 offen
    s_add_u32 s45, s50, 15360
    buffer_load_dwordx4 v[188:191], v31, s[4:7], s45 offen
    s_waitcnt vmcnt(0)
    v_cmp_ne_u32 vcc, v12, v83
    s_mov_b32 s65, 16777216
    s_nop 0
    s_cmp_eq_u64 vcc, 0
    s_cselect_b32 s65, s65, 0
    s_branch L_chk_12
L_try_10:
    s_bitcmp1_b32 s1, 0
    s_cbranch_scc0 L_sk_13
    s_add_u32 s45, s50, 0
    buffer_load_dwordx4 v[128:131], v31, s[4:7], s45 offen sc1
L_sk_13:
    s_bitcmp1_b32 s1, 1
    s_cbranch_scc0 L_sk_14
    s_add_u32 s45, s50, 1024
    buffer_load_dwordx4 v[132:135], v31, s[4:7], s45 offen sc1
L_sk_14:
    s_bitcmp1_b32 s1, 2
    s_cbranch_scc0 L_sk_15
    s_add_u32 s45, s50, 2048
    buffer_load_dwordx4 v[136:139], v31, s[4:7], s45 offen sc1
L_sk_15:
    s_bitcmp1_b32 s1, 3
    s_cbranch_scc0 L_sk_16
    s_add_u32 s45, s50, 3072
    buffer_load_dwordx4 v[140:143], v31, s[4:7], s45 offen sc1
L_sk_16:
    s_bitcmp1_b32 s1, 4
    s_cbranch_scc0 L_sk_17
    s_add_u32 s45, s50, 4096
    buffer_load_dwordx4 v[144:147], v31, s[4:7], s45 offen sc1
L_sk_17:
    s_bitcmp1_b32 s1, 5
    s_cbranch_scc0 L_sk_18
    s_add_u32 s45, s50, 5120
    buffer_load_dwordx4 v[148:151], v31, s[4:7], s45 offen sc1
L_sk_18:
    s_bitcmp1_b32 s1, 6
    s_cbranch_scc0 L_sk_19
    s_add_u32 s45, s50, 6144
    buffer_load_dwordx4 v[152:155], v31, s[4:7], s45 offen sc1
L_sk_19:
    s_bitcmp1_b32 s1, 7
    s_cbranch_scc0 L_sk_20
    s_add_u32 s45, s50, 7168
    buffer_load_dwordx4 v[156:159], v31, s[4:7], s45 offen sc1
L_sk_20:
    s_bitcmp1_b32 s1, 8
    s_cbranch_scc0 L_sk_21
    s_add_u32 s45, s50, 8192
    buffer_load_dwordx4 v[160:163], v31, s[4:7], s45 offen sc1
L_sk_21:
    s_bitcmp1_b32 s1, 9
    s_cbranch_scc0 L_sk_22
    s_add_u32 s45, s50, 9216
    buffer_load_dwordx4 v[164:167], v31, s[4:7], s45 offen sc1
L_sk_22:
    s_bitcmp1_b32 s1, 10
    s_cbranch_scc0 L_sk_23
    s_add_u32 s45, s50, 10240
    buffer_load_dwordx4 v[168:171], v31, s[4:7], s45 offen sc1
L_sk_23:
    s_bitcmp1_b32 s1, 11
    s_cbranch_scc0 L_sk_24
    s_add_u32 s45, s50, 11264
    buffer_load_dwordx4 v[172:175], v31, s[4:7], s45 offen sc1
L_sk_24:
    s_bitcmp1_b32 s1, 12
    s_cbranch_scc0 L_sk_25
    s_add_u32 s45, s50, 12288
    buffer_load_dwordx4 v[176:179], v31, s[4:7], s45 offen sc1
L_sk_25:
    s_bitcmp1_b32 s1, 13
    s_cbranch_scc0 L_sk_26
    s_add_u32 s45, s50, 13312
    buffer_load_dwordx4 v[180:183], v31, s[4:7], s45 offen sc1
L_sk_26:
    s_bitcmp1_b32 s1, 14
    s_cbranch_scc0 L_sk_27
    s_add_u32 s45, s50, 14336
    buffer_load_dwordx4 v[184:187], v31, s[4:7], s45 offen sc1
L_sk_27:
    s_bitcmp1_b32 s1, 15
    s_cbranch_scc0 L_sk_28
    s_add_u32 s45, s50, 15360
    buffer_load_dwordx4 v[188:191], v31, s[4:7], s45 offen sc1
L_sk_28:
    s_waitcnt vmcnt(0)
L_chk_12:
    s_mov_b64 s[32:33], exec
    v_cmpx_eq_u32 vcc, v12, v129
    v_cmpx_eq_u32 vcc, v12, v131
    v_cmpx_eq_u32 vcc, v12, v133
    v_cmpx_eq_u32 vcc, v12, v135
    v_cmpx_eq_u32 vcc, v12, v137
    v_cmpx_eq_u32 vcc, v12, v139
    v_cmpx_eq_u32 vcc, v12, v141
    v_cmpx_eq_u32 vcc, v12, v143
    v_cmpx_eq_u32 vcc, v12, v145
    v_cmpx_eq_u32 vcc, v12, v147
    v_cmpx_eq_u32 vcc, v12, v149
    v_cmpx_eq_u32 vcc, v12, v151
    v_cmpx_eq_u32 vcc, v12, v153
    v_cmpx_eq_u32 vcc, v12, v155
    v_cmpx_eq_u32 vcc, v12, v157
    v_cmpx_eq_u32 vcc, v12, v159
    v_cmpx_eq_u32 vcc, v12, v161
    v_cmpx_eq_u32 vcc, v12, v163
    v_cmpx_eq_u32 vcc, v12, v165
    v_cmpx_eq_u32 vcc, v12, v167
    v_cmpx_eq_u32 vcc, v12, v169
    v_cmpx_eq_u32 vcc, v12, v171
    v_cmpx_eq_u32 vcc, v12, v173
    v_cmpx_eq_u32 vcc, v12, v175
    v_cmpx_eq_u32 vcc, v12, v177
    v_cmpx_eq_u32 vcc, v12, v179
    v_cmpx_eq_u32 vcc, v12, v181
    v_cmpx_eq_u32 vcc, v12, v183
    v_cmpx_eq_u32 vcc, v12, v185
    v_cmpx_eq_u32 vcc, v12, v187
    v_cmpx_eq_u32 vcc, v12, v189
    v_cmpx_eq_u32 vcc, v12, v191
    s_nop 3
    s_cmp_eq_u64 exec, s[32:33]
    s_mov_b64 exec, s[32:33]
    s_cbranch_scc1 L_ok_11
    s_mov_b64 s[32:33], exec
    v_cmpx_eq_u32 vcc, v12, v129
    v_cmpx_eq_u32 vcc, v12, v131
    s_nop 3
    s_cmp_eq_u64 exec, s[32:33]
    s_mov_b64 exec, s[32:33]
    s_cbranch_scc0 L_sk_29
    s_bitset0_b32 s1, 0
L_sk_29:
    s_mov_b64 s[32:33], exec
    v_cmpx_eq_u32 vcc, v12, v133
    v_cmpx_eq_u32 vcc, v12, v135
    s_nop 3
    s_cmp_eq_u64 exec, s[32:33]
    s_mov_b64 exec, s[32:33]
    s_cbranch_scc0 L_sk_30
    s_bitset0_b32 s1, 1
L_sk_30:
    s_mov_b64 s[32:33], exec
    v_cmpx_eq_u32 vcc, v12, v137
    v_cmpx_eq_u32 vcc, v12, v139
    s_nop 3
    s_cmp_eq_u64 exec, s[32:33]
    s_mov_b64 exec, s[32:33]
    s_cbranch_scc0 L_sk_31
    s_bitset0_b32 s1, 2
L_sk_31:
    s_mov_b64 s[32:33], exec
    v_cmpx_eq_u32 vcc, v12, v141
    v_cmpx_eq_u32 vcc, v12, v143
    s_nop 3
    s_cmp_eq_u64 exec, s[32:33]
    s_mov_b64 exec, s[32:33]
    s_cbranch_scc0 L_sk_32
    s_bitset0_b32 s1, 3
L_sk_32:
    s_mov_b64 s[32:33], exec
    v_cmpx_eq_u32 vcc, v12, v145
    v_cmpx_eq_u32 vcc, v12, v147
    s_nop 3
    s_cmp_eq_u64 exec, s[32:33]
    s_mov_b64 exec, s[32:33]
    s_cbranch_scc0 L_sk_33
    s_bitset0_b32 s1, 4
L_sk_33:
    s_mov_b64 s[32:33], exec
    v_cmpx_eq_u32 vcc, v12, v149
    v_cmpx_eq_u32 vcc, v12, v151
    s_nop 3
    s_cmp_eq_u64 exec, s[32:33]
    s_mov_b64 exec, s[32:33]
    s_cbranch_scc0 L_sk_34
    s_bitset0_b32 s1, 5
L_sk_34:
    s_mov_b64 s[32:33], exec
    v_cmpx_eq_u32 vcc, v12, v153
    v_cmpx_eq_u32 vcc, v12, v155
    s_nop 3
    s_cmp_eq_u64 exec, s[32:33]
    s_mov_b64 exec, s[32:33]
    s_cbranch_scc0 L_sk_35
    s_bitset0_b32 s1, 6
L_sk_35:
    s_mov_b64 s[32:33], exec
    v_cmpx_eq_u32 vcc, v12, v157
    v_cmpx_eq_u32 vcc, v12, v159
    s_nop 3
    s_cmp_eq_u64 exec, s[32:33]
    s_mov_b64 exec, s[32:33]
    s_cbranch_scc0 L_sk_36
    s_bitset0_b32 s1, 7
L_sk_36:
    s_mov_b64 s[32:33], exec
    v_cmpx_eq_u32 vcc, v12, v161
    v_cmpx_eq_u32 vcc, v12, v163
    s_nop 3
    s_cmp_eq_u64 exec, s[32:33]
    s_mov_b64 exec, s[32:33]
    s_cbranch_scc0 L_sk_37
    s_bitset0_b32 s1, 8
L_sk_37:
    s_mov_b64 s[32:33], exec
    v_cmpx_eq_u32 vcc, v12, v165
    v_cmpx_eq_u32 vcc, v12, v167
    s_nop 3
    s_cmp_eq_u64 exec, s[32:33]
    s_mov_b64 exec, s[32:33]
    s_cbranch_scc0 L_sk_38
    s_bitset0_b32 s1, 9
L_sk_38:
    s_mov_b64 s[32:33], exec
    v_cmpx_eq_u32 vcc, v12, v169
    v_cmpx_eq_u32 vcc, v12, v171
    s_nop 3
    s_cmp_eq_u64 exec, s[32:33]
    s_mov_b64 exec, s[32:33]
    s_cbranch_scc0 L_sk_39
    s_bitset0_b32 s1, 10
L_sk_39:
    s_mov_b64 s[32:33], exec
    v_cmpx_eq_u32 vcc, v12, v173
    v_cmpx_eq_u32 vcc, v12, v175
    s_nop 3
    s_cmp_eq_u64 exec, s[32:33]
    s_mov_b64 exec, s[32:33]
    s_cbranch_scc0 L_sk_40
    s_bitset0_b32 s1, 11
L_sk_40:
    s_mov_b64 s[32:33], exec
    v_cmpx_eq_u32 vcc, v12, v177
    v_cmpx_eq_u32 vcc, v12, v179
    s_nop 3
    s_cmp_eq_u64 exec, s[32:33]
    s_mov_b64 exec, s[32:33]
    s_cbranch_scc0 L_sk_41
    s_bitset0_b32 s1, 12
L_sk_41:
    s_mov_b64 s[32:33], exec
    v_cmpx_eq_u32 vcc, v12, v181
    v_cmpx_eq_u32 vcc, v12, v183
    s_nop 3
    s_cmp_eq_u64 exec, s[32:33]
    s_mov_b64 exec, s[32:33]
    s_cbranch_scc0 L_sk_42
    s_bitset0_b32 s1, 13
L_sk_42:
    s_mov_b64 s[32:33], exec
    v_cmpx_eq_u32 vcc, v12, v185
    v_cmpx_eq_u32 vcc, v12, v187
    s_nop 3
    s_cmp_eq_u64 exec, s[32:33]
    s_mov_b64 exec, s[32:33]
    s_cbranch_scc0 L_sk_43
    s_bitset0_b32 s1, 14
L_sk_43:
    s_mov_b64 s[32:33], exec
    v_cmpx_eq_u32 vcc, v12, v189
    v_cmpx_eq_u32 vcc, v12, v191
    s_nop 3
    s_cmp_eq_u64 exec, s[32:33]
    s_mov_b64 exec, s[32:33]
    s_cbranch_scc0 L_sk_44
    s_bitset0_b32 s1, 15
L_sk_44:
    s_sub_u32 s48, s48, 1
    s_cmp_eq_u32 s48, 0
    s_cbranch_scc0 L_try_10
    s_mov_b32 s32, s60
    s_mov_b32 s33, s61
    s_mov_b32 s34, 256
    s_mov_b32 s35, 0x20000
    v_mov_b32 v17, 8
    v_mov_b32 v18, 1
    buffer_store_dword v18, v17, s[32:35], 0 offen
    s_waitcnt vmcnt(0)
L_ok_11:
    v_mul_u32_u24 v240, 9216, v3
    v_lshl_add_u32 v241, v2, 4, v240
    v_lshrrev_b32 v17, 3, v2
    v_mul_u32_u24 v17, 1152, v17
    v_and_b32 v18, 7, v2
    v_lshl_add_u32 v17, v18, 4, v17
    v_add_u32 v242, v240, v17
    v_add_u32 v242, 256, v242
    s_and_b32 s52, s63, 3
    s_lshr_b32 s51, s63, 2
    s_lshl_b32 s51, s51, 2
    s_add_u32 s51, s51, s3
    s_mul_i32 s51, s51, 36864
    s_mul_i32 s52, s52, 384
    s_add_u32 s51, s51, s52
    s_add_u32 s52, s51, 4608
    v_xor_b32 v204, 0, v206
    v_mov_b32 v129, v130
    ds_write_b64 v204, v[128:129] offset:0
    v_mov_b32 v133, v134
    ds_write_b64 v204, v[132:133] offset:512
    v_xor_b32 v204, 64, v206
    v_mov_b32 v137, v138
    ds_write_b64 v204, v[136:137] offset:1024
    v_mov_b32 v141, v142
    ds_write_b64 v204, v[140:141] offset:1536
    v_xor_b32 v204, 128, v206
    v_mov_b32 v145, v146
    ds_write_b64 v204, v[144:145] offset:2048
    v_mov_b32 v149, v150
    ds_write_b64 v204, v[148:149] offset:2560
    v_xor_b32 v204, 192, v206
    v_mov_b32 v153, v154
    ds_write_b64 v204, v[152:153] offset:3072
    v_mov_b32 v157, v158
    ds_write_b64 v204, v[156:157] offset:3584
    v_xor_b32 v204, 0, v207
    v_mov_b32 v161, v162
    ds_write_b64 v204, v[160:161] offset:4096
    v_mov_b32 v165, v166
    ds_write_b64 v204, v[164:165] offset:4608
    v_xor_b32 v204, 64, v207
    v_mov_b32 v169, v170
    ds_write_b64 v204, v[168:169] offset:5120
    v_mov_b32 v173, v174
    ds_write_b64 v204, v[172:173] offset:5632
    v_xor_b32 v204, 128, v207
    v_mov_b32 v177, v178
    ds_write_b64 v204, v[176:177] offset:6144
    v_mov_b32 v181, v182
    ds_write_b64 v204, v[180:181] offset:6656
    v_xor_b32 v204, 192, v207
    v_mov_b32 v185, v186
    ds_write_b64 v204, v[184:185] offset:7168
    v_mov_b32 v189, v190
    ds_write_b64 v204, v[188:189] offset:7680
    s_waitcnt lgkmcnt(0)
    s_barrier
    ds_read_b128 v[80:83], v112 offset:0
    ds_read_b128 v[84:87], v120 offset:0
    ds_read_b128 v[88:91], v113 offset:0
    ds_read_b128 v[92:95], v121 offset:0
    ds_read_b128 v[96:99], v114 offset:0
    ds_read_b128 v[100:103], v122 offset:0
    ds_read_b128 v[104:107], v115 offset:0
    ds_read_b128 v[108:111], v123 offset:0
    v_lshlrev_b32 v208, 16, v3
    v_lshl_add_u32 v208, v2, 4, v208
    s_and_b32 s42, s63, 3
    s_lshl_b32 s42, s42, 7
    s_lshl_b32 s44, s3, 5
    s_add_u32 s42, s42, s44
    s_lshl_b32 s42, s42, 13
    s_lshl_b32 s44, s49, 8
    s_add_u32 s42, s42, s44
    buffer_load_dwordx4 a[32:35], v208, s[20:23], s42 offen nt
    s_add_u32 s42, s42, 8192
    buffer_load_dwordx4 a[36:39], v208, s[20:23], s42 offen nt
    s_add_u32 s42, s42, 8192
    buffer_load_dwordx4 a[40:43], v208, s[20:23], s42 offen nt
    s_add_u32 s42, s42, 8192
    buffer_load_dwordx4 a[44:47], v208, s[20:23], s42 offen nt
    s_add_u32 s42, s42, 8192
    buffer_load_dwordx4 a[48:51], v208, s[20:23], s42 offen nt
    s_add_u32 s42, s42, 8192
    buffer_load_dwordx4 a[52:55], v208, s[20:23], s42 offen nt
    s_add_u32 s42, s42, 8192
    buffer_load_dwordx4 a[56:59], v208, s[20:23], s42 offen nt
    s_add_u32 s42, s42, 8192
    buffer_load_dwordx4 a[60:63], v208, s[20:23], s42 offen nt
    s_waitcnt lgkmcnt(6)
    v_mfma_f32_32x32x16_bf16 v[64:79], v[80:83], v[84:87], 0
    ds_read_b128 v[80:83], v116 offset:0
    ds_read_b128 v[84:87], v124 offset:0
    s_waitcnt lgkmcnt(6)
    v_mfma_f32_32x32x16_bf16 v[64:79], v[88:91], v[92:95], v[64:79]
    ds_read_b128 v[88:91], v117 offset:0
    ds_read_b128 v[92:95], v125 offset:0
    s_waitcnt lgkmcnt(6)
    v_mfma_f32_32x32x16_bf16 v[64:79], v[96:99], v[100:103], v[64:79]
    ds_read_b128 v[96:99], v118 offset:0
    ds_read_b128 v[100:103], v126 offset:0
    s_waitcnt lgkmcnt(6)
    v_mfma_f32_32x32x16_bf16 v[64:79], v[104:107], v[108:111], v[64:79]
    ds_read_b128 v[104:107], v119 offset:0
    ds_read_b128 v[108:111], v127 offset:0
    s_waitcnt lgkmcnt(6)
    v_mfma_f32_32x32x16_bf16 v[64:79], v[80:83], v[84:87], v[64:79]
    ds_read_b128 v[80:83], v112 offset:256
    ds_read_b128 v[84:87], v120 offset:256
    s_waitcnt lgkmcnt(6)
    v_mfma_f32_32x32x16_bf16 v[64:79], v[88:91], v[92:95], v[64:79]
    ds_read_b128 v[88:91], v113 offset:256
    ds_read_b128 v[92:95], v121 offset:256
    s_waitcnt lgkmcnt(6)
    v_mfma_f32_32x32x16_bf16 v[64:79], v[96:99], v[100:103], v[64:79]
    ds_read_b128 v[96:99], v114 offset:256
    ds_read_b128 v[100:103], v122 offset:256
    s_waitcnt lgkmcnt(6)
    v_mfma_f32_32x32x16_bf16 v[64:79], v[104:107], v[108:111], v[64:79]
    ds_read_b128 v[104:107], v115 offset:256
    ds_read_b128 v[108:111], v123 offset:256
    s_waitcnt lgkmcnt(6)
    v_mfma_f32_32x32x16_bf16 v[64:79], v[80:83], v[84:87], v[64:79]
    ds_read_b128 v[80:83], v116 offset:256
    ds_read_b128 v[84:87], v124 offset:256
    s_waitcnt lgkmcnt(6)
    v_mfma_f32_32x32x16_bf16 v[64:79], v[88:91], v[92:95], v[64:79]
    ds_read_b128 v[88:91], v117 offset:256
    ds_read_b128 v[92:95], v125 offset:256
    s_waitcnt lgkmcnt(6)
    v_mfma_f32_32x32x16_bf16 v[64:79], v[96:99], v[100:103], v[64:79]
    ds_read_b128 v[96:99], v118 offset:256
    ds_read_b128 v[100:103], v126 offset:256
    s_waitcnt lgkmcnt(6)
    v_mfma_f32_32x32x16_bf16 v[64:79], v[104:107], v[108:111], v[64:79]
    ds_read_b128 v[104:107], v119 offset:256
    ds_read_b128 v[108:111], v127 offset:256
    s_waitcnt lgkmcnt(6)
    v_mfma_f32_32x32x16_bf16 v[64:79], v[80:83], v[84:87], v[64:79]
    ds_read_b128 v[80:83], v112 offset:512
    ds_read_b128 v[84:87], v120 offset:512
    s_waitcnt lgkmcnt(6)
    v_mfma_f32_32x32x16_bf16 v[64:79], v[88:91], v[92:95], v[64:79]
    ds_read_b128 v[88:91], v113 offset:512
    ds_read_b128 v[92:95], v121 offset:512
    s_waitcnt lgkmcnt(6)
    v_mfma_f32_32x32x16_bf16 v[64:79], v[96:99], v[100:103], v[64:79]
    ds_read_b128 v[96:99], v114 offset:512
    ds_read_b128 v[100:103], v122 offset:512
    s_waitcnt lgkmcnt(6)
    v_mfma_f32_32x32x16_bf16 v[64:79], v[104:107], v[108:111], v[64:79]
    ds_read_b128 v[104:107], v115 offset:512
    ds_read_b128 v[108:111], v123 offset:512
    s_waitcnt lgkmcnt(6)
    v_mfma_f32_32x32x16_bf16 v[64:79], v[80:83], v[84:87], v[64:79]
    ds_read_b128 v[80:83], v116 offset:512
    ds_read_b128 v[84:87], v124 offset:512
    s_waitcnt lgkmcnt(6)
    v_mfma_f32_32x32x16_bf16 v[64:79], v[88:91], v[92:95], v[64:79]
    ds_read_b128 v[88:91], v117 offset:512
    ds_read_b128 v[92:95], v125 offset:512
    s_waitcnt lgkmcnt(6)
    v_mfma_f32_32x32x16_bf16 v[64:79], v[96:99], v[100:103], v[64:79]
    ds_read_b128 v[96:99], v118 offset:512
    ds_read_b128 v[100:103], v126 offset:512
    s_waitcnt lgkmcnt(6)
    v_mfma_f32_32x32x16_bf16 v[64:79], v[104:107], v[108:111], v[64:79]
    ds_read_b128 v[104:107], v119 offset:512
    ds_read_b128 v[108:111], v127 offset:512
    s_waitcnt lgkmcnt(6)
    v_mfma_f32_32x32x16_bf16 v[64:79], v[80:83], v[84:87], v[64:79]
    ds_read_b128 v[80:83], v112 offset:768
    ds_read_b128 v[84:87], v120 offset:768
    s_waitcnt lgkmcnt(6)
    v_mfma_f32_32x32x16_bf16 v[64:79], v[88:91], v[92:95], v[64:79]
    ds_read_b128 v[88:91], v113 offset:768
    ds_read_b128 v[92:95], v121 offset:768
    s_waitcnt lgkmcnt(6)
    v_mfma_f32_32x32x16_bf16 v[64:79], v[96:99], v[100:103], v[64:79]
    ds_read_b128 v[96:99], v114 offset:768
    ds_read_b128 v[100:103], v122 offset:768
    s_waitcnt lgkmcnt(6)
    v_mfma_f32_32x32x16_bf16 v[64:79], v[104:107], v[108:111], v[64:79]
    ds_read_b128 v[104:107], v115 offset:768
    ds_read_b128 v[108:111], v123 offset:768
    s_waitcnt lgkmcnt(6)
    v_mfma_f32_32x32x16_bf16 v[64:79], v[80:83], v[84:87], v[64:79]
    ds_read_b128 v[80:83], v116 offset:768
    ds_read_b128 v[84:87], v124 offset:768
    s_waitcnt lgkmcnt(6)
    v_mfma_f32_32x32x16_bf16 v[64:79], v[88:91], v[92:95], v[64:79]
    ds_read_b128 v[88:91], v117 offset:768
    ds_read_b128 v[92:95], v125 offset:768
    s_waitcnt lgkmcnt(6)
    v_mfma_f32_32x32x16_bf16 v[64:79], v[96:99], v[100:103], v[64:79]
    ds_read_b128 v[96:99], v118 offset:768
    ds_read_b128 v[100:103], v126 offset:768
    s_waitcnt lgkmcnt(6)
    v_mfma_f32_32x32x16_bf16 v[64:79], v[104:107], v[108:111], v[64:79]
    ds_read_b128 v[104:107], v119 offset:768
    ds_read_b128 v[108:111], v127 offset:768
    s_waitcnt lgkmcnt(6)
    v_mfma_f32_32x32x16_bf16 v[64:79], v[80:83], v[84:87], v[64:79]
    s_waitcnt lgkmcnt(4)
    v_mfma_f32_32x32x16_bf16 v[64:79], v[88:91], v[92:95], v[64:79]
    s_waitcnt lgkmcnt(2)
    v_mfma_f32_32x32x16_bf16 v[64:79], v[96:99], v[100:103], v[64:79]
    s_waitcnt lgkmcnt(0)
    v_mfma_f32_32x32x16_bf16 v[64:79], v[104:107], v[108:111], v[64:79]
    s_lshl_b32 s42, s3, 7
    v_add_u32 v205, s42, v243
    s_nop 9
    v_max3_f32 v196, v64, v65, v66
    v_max3_f32 v196, v196, v67, v68
    v_max3_f32 v196, v196, v69, v70
    v_max3_f32 v196, v196, v71, v72
    v_max3_f32 v196, v196, v73, v74
    v_max3_f32 v196, v196, v75, v76
    v_max3_f32 v196, v196, v77, v78
    v_max_f32 v196, v196, v79
    v_mov_b32 v17, v196
    s_nop 1
    v_permlane32_swap_b32 v196, v17
    v_max_f32 v196, v196, v17
    s_waitcnt lgkmcnt(0)
    s_barrier
    ds_write_b32 v205, v196 offset:0
    s_waitcnt lgkmcnt(0)
    s_barrier
    ds_read_b32 v80, v243 offset:0
    ds_read_b32 v81, v243 offset:128
    ds_read_b32 v82, v243 offset:256
    ds_read_b32 v83, v243 offset:384
    s_lshl_b32 s42, s3, 11
    s_add_u32 s42, s42, 131072
    v_add_u32 v204, s42, v31
    s_waitcnt lgkmcnt(0)
    v_max3_f32 v196, v80, v81, v82
    v_max_f32 v196, v196, v83
    v_mul_f32 v196, s58, v196
    v_fma_f32 v64, v64, s58, -v196
    v_fma_f32 v65, v65, s58, -v196
    v_fma_f32 v66, v66, s58, -v196
    v_fma_f32 v67, v67, s58, -v196
    v_fma_f32 v68, v68, s58, -v196
    v_fma_f32 v69, v69, s58, -v196
    v_fma_f32 v70, v70, s58, -v196
    v_fma_f32 v71, v71, s58, -v196
    v_fma_f32 v72, v72, s58, -v196
    v_fma_f32 v73, v73, s58, -v196
    v_fma_f32 v74, v74, s58, -v196
    v_fma_f32 v75, v75, s58, -v196
    v_fma_f32 v76, v76, s58, -v196
    v_fma_f32 v77, v77, s58, -v196
    v_fma_f32 v78, v78, s58, -v196
    v_fma_f32 v79, v79, s58, -v196
    v_exp_f32 v64, v64
    v_exp_f32 v65, v65
    v_exp_f32 v66, v66
    v_exp_f32 v67, v67
    v_exp_f32 v68, v68
    v_exp_f32 v69, v69
    v_exp_f32 v70, v70
    v_exp_f32 v71, v71
    v_exp_f32 v72, v72
    v_exp_f32 v73, v73
    v_exp_f32 v74, v74
    v_exp_f32 v75, v75
    v_exp_f32 v76, v76
    v_exp_f32 v77, v77
    v_exp_f32 v78, v78
    v_exp_f32 v79, v79
    v_cvt_pk_bf16_f32 v80, v64, v65
    v_cvt_pk_bf16_f32 v81, v66, v67
    v_cvt_pk_bf16_f32 v82, v68, v69
    v_cvt_pk_bf16_f32 v83, v70, v71
    ds_write_b128 v204, v[80:83] offset:1024
    v_cvt_pk_bf16_f32 v84, v72, v73
    v_cvt_pk_bf16_f32 v85, v74, v75
    v_cvt_pk_bf16_f32 v86, v76, v77
    v_cvt_pk_bf16_f32 v87, v78, v79
    ds_write_b128 v204, v[84:87] offset:2048
    v_add_f32 v197, v64, v65
    v_add_f32 v197, v197, v66
    v_add_f32 v197, v197, v67
    v_add_f32 v197, v197, v68
    v_add_f32 v197, v197, v69
    v_add_f32 v197, v197, v70
    v_add_f32 v197, v197, v71
    v_add_f32 v197, v197, v72
    v_add_f32 v197, v197, v73
    v_add_f32 v197, v197, v74
    v_add_f32 v197, v197, v75
    v_add_f32 v197, v197, v76
    v_add_f32 v197, v197, v77
    v_add_f32 v197, v197, v78
    v_add_f32 v197, v197, v79
    v_mov_b32 v18, v197
    s_nop 1
    v_permlane32_swap_b32 v197, v18
    v_add_f32 v197, v197, v18
    ds_write_b32 v205, v197 offset:512
    v_add_u32 v204, 131072, v31
    s_waitcnt lgkmcnt(0)
    s_barrier
    ds_read_b128 v[208:211], v204 offset:1024
    ds_read_b128 v[212:215], v204 offset:2048
    ds_read_b128 v[216:219], v204 offset:3072
    ds_read_b128 v[220:223], v204 offset:4096
    ds_read_b128 v[224:227], v204 offset:5120
    ds_read_b128 v[228:231], v204 offset:6144
    ds_read_b128 v[232:235], v204 offset:7168
    ds_read_b128 v[236:239], v204 offset:8192
    ds_read_b32 v80, v243 offset:512
    ds_read_b32 v81, v243 offset:640
    ds_read_b32 v82, v243 offset:768
    ds_read_b32 v83, v243 offset:896
    s_waitcnt lgkmcnt(0)
    v_add_f32 v80, v80, v81
    v_add_f32 v82, v82, v83
    v_add_f32 v197, v80, v82
    ds_read_b64_tr_b16 v[80:81], v244 offset:0
    ds_read_b64_tr_b16 v[82:83], v245 offset:0
    ds_read_b64_tr_b16 v[84:85], v246 offset:0
    ds_read_b64_tr_b16 v[86:87], v247 offset:0
    ds_read_b64_tr_b16 v[88:89], v248 offset:0
    ds_read_b64_tr_b16 v[90:91], v249 offset:0
    ds_read_b64_tr_b16 v[92:93], v250 offset:0
    ds_read_b64_tr_b16 v[94:95], v251 offset:0
    ds_read_b64_tr_b16 v[96:97], v244 offset:16384
    ds_read_b64_tr_b16 v[98:99], v245 offset:16384
    ds_read_b64_tr_b16 v[100:101], v246 offset:16384
    ds_read_b64_tr_b16 v[102:103], v247 offset:16384
    s_waitcnt lgkmcnt(10)
    v_mfma_f32_32x32x16_bf16 v[128:143], v[208:211], v[80:83], 0
    ds_read_b64_tr_b16 v[80:81], v248 offset:16384
    ds_read_b64_tr_b16 v[82:83], v249 offset:16384
    s_waitcnt lgkmcnt(10)
    v_mfma_f32_32x32x16_bf16 v[144:159], v[208:211], v[84:87], 0
    ds_read_b64_tr_b16 v[84:85], v250 offset:16384
    ds_read_b64_tr_b16 v[86:87], v251 offset:16384
    s_waitcnt lgkmcnt(10)
    v_mfma_f32_32x32x16_bf16 v[160:175], v[208:211], v[88:91], 0
    ds_read_b64_tr_b16 v[88:89], v244 offset:32768
    ds_read_b64_tr_b16 v[90:91], v245 offset:32768
    s_waitcnt lgkmcnt(10)
    v_mfma_f32_32x32x16_bf16 v[176:191], v[208:211], v[92:95], 0
    ds_read_b64_tr_b16 v[92:93], v246 offset:32768
    ds_read_b64_tr_b16 v[94:95], v247 offset:32768
    s_waitcnt lgkmcnt(10)
    v_mfma_f32_32x32x16_bf16 v[128:143], v[212:215], v[96:99], v[128:143]
    ds_read_b64_tr_b16 v[96:97], v248 offset:32768
    ds_read_b64_tr_b16 v[98:99], v249 offset:32768
    s_waitcnt lgkmcnt(10)
    v_mfma_f32_32x32x16_bf16 v[144:159], v[212:215], v[100:103], v[144:159]
    ds_read_b64_tr_b16 v[100:101], v250 offset:32768
    ds_read_b64_tr_b16 v[102:103], v251 offset:32768
    s_waitcnt lgkmcnt(10)
    v_mfma_f32_32x32x16_bf16 v[160:175], v[212:215], v[80:83], v[160:175]
    ds_read_b64_tr_b16 v[80:81], v244 offset:49152
    ds_read_b64_tr_b16 v[82:83], v245 offset:49152
    s_waitcnt lgkmcnt(10)
    v_mfma_f32_32x32x16_bf16 v[176:191], v[212:215], v[84:87], v[176:191]
    ds_read_b64_tr_b16 v[84:85], v246 offset:49152
    ds_read_b64_tr_b16 v[86:87], v247 offset:49152
    s_waitcnt lgkmcnt(10)
    v_mfma_f32_32x32x16_bf16 v[128:143], v[216:219], v[88:91], v[128:143]
    ds_read_b64_tr_b16 v[88:89], v248 offset:49152
    ds_read_b64_tr_b16 v[90:91], v249 offset:49152
    v_lshrrev_b32 v17, 5, v1
    v_lshlrev_b32 v205, 19, v17
    v_and_b32 v17, 31, v1
    v_lshl_add_u32 v205, v17, 3, v205
    s_sub_u32 s43, s2, 128
    s_lshl_b32 s43, s43, 8
    s_lshl_b32 s42, s3, 15
    s_add_u32 s43, s43, s42
    s_add_u32 s43, s43, 4194304
    s_waitcnt lgkmcnt(10)
    v_mfma_f32_32x32x16_bf16 v[144:159], v[216:219], v[92:95], v[144:159]
    ds_read_b64_tr_b16 v[92:93], v250 offset:49152
    ds_read_b64_tr_b16 v[94:95], v251 offset:49152
    s_waitcnt lgkmcnt(10)
    v_mfma_f32_32x32x16_bf16 v[160:175], v[216:219], v[96:99], v[160:175]
    v_add_u32 v244, 65536, v244
    v_add_u32 v245, 65536, v245
    v_add_u32 v246, 65536, v246
    v_add_u32 v247, 65536, v247
    v_add_u32 v248, 65536, v248
    v_add_u32 v249, 65536, v249
    v_add_u32 v250, 65536, v250
    v_add_u32 v251, 65536, v251
    ds_read_b64_tr_b16 v[96:97], v244 offset:0
    ds_read_b64_tr_b16 v[98:99], v245 offset:0
    s_waitcnt lgkmcnt(10)
    v_mfma_f32_32x32x16_bf16 v[176:191], v[216:219], v[100:103], v[176:191]
    ds_read_b64_tr_b16 v[100:101], v246 offset:0
    ds_read_b64_tr_b16 v[102:103], v247 offset:0
    s_waitcnt lgkmcnt(10)
    v_mfma_f32_32x32x16_bf16 v[128:143], v[220:223], v[80:83], v[128:143]
    ds_read_b64_tr_b16 v[80:81], v248 offset:0
    ds_read_b64_tr_b16 v[82:83], v249 offset:0
    s_waitcnt lgkmcnt(10)
    v_mfma_f32_32x32x16_bf16 v[144:159], v[220:223], v[84:87], v[144:159]
    ds_read_b64_tr_b16 v[84:85], v250 offset:0
    ds_read_b64_tr_b16 v[86:87], v251 offset:0
    s_waitcnt lgkmcnt(10)
    v_mfma_f32_32x32x16_bf16 v[160:175], v[220:223], v[88:91], v[160:175]
    ds_read_b64_tr_b16 v[88:89], v244 offset:16384
    ds_read_b64_tr_b16 v[90:91], v245 offset:16384
    s_waitcnt lgkmcnt(10)
    v_mfma_f32_32x32x16_bf16 v[176:191], v[220:223], v[92:95], v[176:191]
    ds_read_b64_tr_b16 v[92:93], v246 offset:16384
    ds_read_b64_tr_b16 v[94:95], v247 offset:16384
    s_waitcnt lgkmcnt(10)
    v_mfma_f32_32x32x16_bf16 v[128:143], v[224:227], v[96:99], v[128:143]
    ds_read_b64_tr_b16 v[96:97], v248 offset:16384
    ds_read_b64_tr_b16 v[98:99], v249 offset:16384
    s_waitcnt lgkmcnt(10)
    v_mfma_f32_32x32x16_bf16 v[144:159], v[224:227], v[100:103], v[144:159]
    ds_read_b64_tr_b16 v[100:101], v250 offset:16384
    ds_read_b64_tr_b16 v[102:103], v251 offset:16384
    s_waitcnt lgkmcnt(10)
    v_mfma_f32_32x32x16_bf16 v[160:175], v[224:227], v[80:83], v[160:175]
    ds_read_b64_tr_b16 v[80:81], v244 offset:32768
    ds_read_b64_tr_b16 v[82:83], v245 offset:32768
    s_waitcnt lgkmcnt(10)
    v_mfma_f32_32x32x16_bf16 v[176:191], v[224:227], v[84:87], v[176:191]
    ds_read_b64_tr_b16 v[84:85], v246 offset:32768
    ds_read_b64_tr_b16 v[86:87], v247 offset:32768
    s_waitcnt lgkmcnt(10)
    v_mfma_f32_32x32x16_bf16 v[128:143], v[228:231], v[88:91], v[128:143]
    ds_read_b64_tr_b16 v[88:89], v248 offset:32768
    ds_read_b64_tr_b16 v[90:91], v249 offset:32768
    s_waitcnt lgkmcnt(10)
    v_mfma_f32_32x32x16_bf16 v[144:159], v[228:231], v[92:95], v[144:159]
    ds_read_b64_tr_b16 v[92:93], v250 offset:32768
    ds_read_b64_tr_b16 v[94:95], v251 offset:32768
    s_waitcnt lgkmcnt(10)
    v_mfma_f32_32x32x16_bf16 v[160:175], v[228:231], v[96:99], v[160:175]
    ds_read_b64_tr_b16 v[96:97], v244 offset:49152
    ds_read_b64_tr_b16 v[98:99], v245 offset:49152
    s_waitcnt lgkmcnt(10)
    v_mfma_f32_32x32x16_bf16 v[176:191], v[228:231], v[100:103], v[176:191]
    ds_read_b64_tr_b16 v[100:101], v246 offset:49152
    ds_read_b64_tr_b16 v[102:103], v247 offset:49152
    s_waitcnt lgkmcnt(10)
    v_mfma_f32_32x32x16_bf16 v[128:143], v[232:235], v[80:83], v[128:143]
    ds_read_b64_tr_b16 v[80:81], v248 offset:49152
    ds_read_b64_tr_b16 v[82:83], v249 offset:49152
    s_waitcnt lgkmcnt(10)
    v_mfma_f32_32x32x16_bf16 v[144:159], v[232:235], v[84:87], v[144:159]
    ds_read_b64_tr_b16 v[84:85], v250 offset:49152
    ds_read_b64_tr_b16 v[86:87], v251 offset:49152
    s_waitcnt lgkmcnt(10)
    v_mfma_f32_32x32x16_bf16 v[160:175], v[232:235], v[88:91], v[160:175]
    s_waitcnt lgkmcnt(8)
    v_mfma_f32_32x32x16_bf16 v[176:191], v[232:235], v[92:95], v[176:191]
    s_waitcnt lgkmcnt(6)
    v_mfma_f32_32x32x16_bf16 v[128:143], v[236:239], v[96:99], v[128:143]
    s_waitcnt lgkmcnt(4)
    v_mfma_f32_32x32x16_bf16 v[144:159], v[236:239], v[100:103], v[144:159]
    s_waitcnt lgkmcnt(2)
    v_mfma_f32_32x32x16_bf16 v[160:175], v[236:239], v[80:83], v[160:175]
    s_waitcnt lgkmcnt(0)
    v_mfma_f32_32x32x16_bf16 v[176:191], v[236:239], v[84:87], v[176:191]
    s_nop 7
    v_cvt_pk_bf16_f32 v80, v128, v144
    s_nop 2
    v_cvt_pk_bf16_f32 v81, v160, v176
    s_add_u32 s42, s43, 0
    buffer_store_dwordx2 v[80:81], v205, s[4:7], s42 offen sc1
    v_cvt_pk_bf16_f32 v82, v129, v145
    v_cvt_pk_bf16_f32 v83, v161, v177
    s_add_u32 s42, s43, 131072
    buffer_store_dwordx2 v[82:83], v205, s[4:7], s42 offen sc1
    v_cvt_pk_bf16_f32 v84, v130, v146
    v_cvt_pk_bf16_f32 v85, v162, v178
    s_add_u32 s42, s43, 262144
    buffer_store_dwordx2 v[84:85], v205, s[4:7], s42 offen sc1
    v_cvt_pk_bf16_f32 v86, v131, v147
    v_cvt_pk_bf16_f32 v87, v163, v179
    s_add_u32 s42, s43, 393216
    buffer_store_dwordx2 v[86:87], v205, s[4:7], s42 offen sc1
    v_cvt_pk_bf16_f32 v88, v132, v148
    v_cvt_pk_bf16_f32 v89, v164, v180
    s_add_u32 s42, s43, 1048576
    buffer_store_dwordx2 v[88:89], v205, s[4:7], s42 offen sc1
    v_cvt_pk_bf16_f32 v90, v133, v149
    v_cvt_pk_bf16_f32 v91, v165, v181
    s_add_u32 s42, s43, 1179648
    buffer_store_dwordx2 v[90:91], v205, s[4:7], s42 offen sc1
    v_cvt_pk_bf16_f32 v92, v134, v150
    v_cvt_pk_bf16_f32 v93, v166, v182
    s_add_u32 s42, s43, 1310720
    buffer_store_dwordx2 v[92:93], v205, s[4:7], s42 offen sc1
    v_cvt_pk_bf16_f32 v94, v135, v151
    v_cvt_pk_bf16_f32 v95, v167, v183
    s_add_u32 s42, s43, 1441792
    buffer_store_dwordx2 v[94:95], v205, s[4:7], s42 offen sc1
    v_cvt_pk_bf16_f32 v80, v136, v152
    v_cvt_pk_bf16_f32 v81, v168, v184
    s_add_u32 s42, s43, 2097152
    buffer_store_dwordx2 v[80:81], v205, s[4:7], s42 offen sc1
    v_cvt_pk_bf16_f32 v82, v137, v153
    v_cvt_pk_bf16_f32 v83, v169, v185
    s_add_u32 s42, s43, 2228224
    buffer_store_dwordx2 v[82:83], v205, s[4:7], s42 offen sc1
    v_cvt_pk_bf16_f32 v84, v138, v154
    v_cvt_pk_bf16_f32 v85, v170, v186
    s_add_u32 s42, s43, 2359296
    buffer_store_dwordx2 v[84:85], v205, s[4:7], s42 offen sc1
    v_cvt_pk_bf16_f32 v86, v139, v155
    v_cvt_pk_bf16_f32 v87, v171, v187
    s_add_u32 s42, s43, 2490368
    buffer_store_dwordx2 v[86:87], v205, s[4:7], s42 offen sc1
    v_cvt_pk_bf16_f32 v88, v140, v156
    v_cvt_pk_bf16_f32 v89, v172, v188
    s_add_u32 s42, s43, 3145728
    buffer_store_dwordx2 v[88:89], v205, s[4:7], s42 offen sc1
    v_cvt_pk_bf16_f32 v90, v141, v157
    v_cvt_pk_bf16_f32 v91, v173, v189
    s_add_u32 s42, s43, 3276800
    buffer_store_dwordx2 v[90:91], v205, s[4:7], s42 offen sc1
    v_cvt_pk_bf16_f32 v92, v142, v158
    v_cvt_pk_bf16_f32 v93, v174, v190
    s_add_u32 s42, s43, 3407872
    buffer_store_dwordx2 v[92:93], v205, s[4:7], s42 offen sc1
    v_cvt_pk_bf16_f32 v94, v143, v159
    v_cvt_pk_bf16_f32 v95, v175, v191
    s_add_u32 s42, s43, 3538944
    buffer_store_dwordx2 v[94:95], v205, s[4:7], s42 offen sc1
    v_mov_b32 v80, v196
    v_mov_b32 v81, v12
    v_mov_b32 v82, v197
    v_mov_b32 v83, v12
    v_lshlrev_b32 v17, 11, v1
    s_sub_u32 s43, s2, 128
    s_lshl_b32 s43, s43, 4
    s_add_u32 s43, s43, 1376256
    s_lshl_b32 s50, s49, 11
    s_add_u32 s50, s50, 1376256
    v_lshlrev_b32 v204, 4, v0
    s_waitcnt vmcnt(0)
    s_barrier
    v_cmp_gt_u32 vcc, 32, v0
    s_nop 0
    s_and_saveexec_b64 s[32:33], vcc
    s_cbranch_execz L_b_noml
    buffer_store_dwordx4 v[80:83], v17, s[4:7], s43 offen sc1
L_b_noml:
    s_mov_b64 exec, s[32:33]
    buffer_load_dwordx4 a[128:131], v241, s[24:27], s51 offen offset:0 nt
    buffer_load_dwordx4 a[132:135], v241, s[24:27], s51 offen offset:1152 nt
    buffer_load_dwordx4 a[136:139], v241, s[24:27], s51 offen offset:2304 nt
    buffer_load_dwordx4 a[140:143], v241, s[24:27], s51 offen offset:3456 nt
    buffer_load_dwordx4 a[144:147], v241, s[24:27], s52 offen offset:0 nt
    buffer_load_dwordx4 a[148:151], v241, s[24:27], s52 offen offset:1152 nt
    buffer_load_dwordx4 a[152:155], v241, s[24:27], s52 offen offset:2304 nt
    buffer_load_dwordx4 a[156:159], v241, s[24:27], s52 offen offset:3456 nt
    buffer_load_dwordx4 a[160:163], v242, s[24:27], s51 offen offset:0 nt
    buffer_load_dwordx4 a[164:167], v242, s[24:27], s51 offen offset:2304 nt
    buffer_load_dwordx4 a[168:171], v242, s[24:27], s52 offen offset:0 nt
    buffer_load_dwordx4 a[172:175], v242, s[24:27], s52 offen offset:2304 nt
    s_cmp_ge_u32 s3, 2
    s_cbranch_scc1 L_b_polled
    buffer_load_dwordx4 v[80:83], v204, s[4:7], s50 offen sc1
    s_waitcnt vmcnt(0)
    s_mov_b32 s48, 3000000
L_chk_45:
    s_mov_b64 s[32:33], exec
    v_cmpx_eq_u32 vcc, v12, v81
    v_cmpx_eq_u32 vcc, v12, v83
    s_nop 3
    s_cmp_eq_u64 exec, s[32:33]
    s_mov_b64 exec, s[32:33]
    s_cbranch_scc1 L_ok_46
    s_sub_u32 s48, s48, 1
    s_cmp_eq_u32 s48, 0
    s_cbranch_scc1 L_to_47
    buffer_load_dwordx4 v[80:83], v204, s[4:7], s50 offen sc1
    s_waitcnt vmcnt(0)
    s_branch L_chk_45
L_to_47:
    s_mov_b32 s32, s60
    s_mov_b32 s33, s61
    s_mov_b32 s34, 256
    s_mov_b32 s35, 0x20000
    v_mov_b32 v17, 12
    v_mov_b32 v18, 1
    buffer_store_dword v18, v17, s[32:35], 0 offen
    s_waitcnt vmcnt(0)
L_ok_46:
L_b_polled:
    s_lshl_b32 s56, s63, 15
    s_lshl_b32 s43, s3, 13
    s_add_u32 s56, s56, s43
    s_add_u32 s56, s56, 4194304
    v_lshlrev_b32 v206, 11, v3
    v_lshl_add_u32 v206, v2, 4, v206
    s_barrier
    buffer_load_dwordx4 v[128:131], v206, s[4:7], s56 offen offset:0 sc1
    buffer_load_dwordx4 v[132:135], v206, s[4:7], s56 offen offset:256 sc1
    buffer_load_dwordx4 v[136:139], v206, s[4:7], s56 offen offset:512 sc1
    buffer_load_dwordx4 v[140:143], v206, s[4:7], s56 offen offset:768 sc1
    buffer_load_dwordx4 v[144:147], v206, s[4:7], s56 offen offset:1024 sc1
    buffer_load_dwordx4 v[148:151], v206, s[4:7], s56 offen offset:1280 sc1
    buffer_load_dwordx4 v[152:155], v206, s[4:7], s56 offen offset:1536 sc1
    buffer_load_dwordx4 v[156:159], v206, s[4:7], s56 offen offset:1792 sc1
    s_cmp_ge_u32 s3, 2
    s_cbranch_scc1 L_b_skipml
    v_mov_b32 v84, v80
    s_nop 1
    v_max_f32_dpp v84, v84, v84 quad_perm:[1,0,3,2] row_mask:0xf bank_mask:0xf
    s_nop 1
    v_max_f32_dpp v84, v84, v84 quad_perm:[2,3,0,1] row_mask:0xf bank_mask:0xf
    s_nop 1
    v_max_f32_dpp v84, v84, v84 row_half_mirror row_mask:0xf bank_mask:0xf
    s_nop 1
    v_max_f32_dpp v84, v84, v84 row_mirror row_mask:0xf bank_mask:0xf
    v_mov_b32 v17, v84
    s_nop 1
    v_permlane16_swap_b32 v84, v17
    v_max_f32 v84, v84, v17
    v_mov_b32 v17, v84
    s_nop 1
    v_permlane32_swap_b32 v84, v17
    v_max_f32 v84, v84, v17
    v_sub_f32 v80, v80, v84
    v_exp_f32 v80, v80
    v_lshlrev_b32 v19, 1, v0
    v_mul_f32 v85, v80, v82
    s_nop 1
    v_add_f32_dpp v85, v85, v85 quad_perm:[1,0,3,2] row_mask:0xf bank_mask:0xf
    s_nop 1
    v_add_f32_dpp v85, v85, v85 quad_perm:[2,3,0,1] row_mask:0xf bank_mask:0xf
    s_nop 1
    v_add_f32_dpp v85, v85, v85 row_half_mirror row_mask:0xf bank_mask:0xf
    s_nop 1
    v_add_f32_dpp v85, v85, v85 row_mirror row_mask:0xf bank_mask:0xf
    v_mov_b32 v17, v85
    s_nop 1
    v_permlane16_swap_b32 v85, v17
    v_add_f32 v85, v85, v17
    v_mov_b32 v17, v85
    s_nop 1
    v_permlane32_swap_b32 v85, v17
    v_add_f32 v85, v85, v17
    v_rcp_f32 v85, v85
    v_add_u32 v19, 131072, v19
    v_mul_f32 v80, v80, v85
    v_cvt_pk_bf16_f32 v80, v80, v80
    ds_write_b16 v19, v80 offset:0
    s_waitcnt lgkmcnt(0)
L_b_skipml:
    s_lshl_b32 s42, s63, 15
    s_lshl_b32 s43, s3, 13
    s_add_u32 s42, s42, s43
    s_add_u32 s42, s42, 4194304
    v_lshlrev_b32 v204, 11, v3
    v_lshl_add_u32 v204, v2, 4, v204
    s_lshl_b32 s43, s3, 6
    s_add_u32 s43, s43, 131072
    v_lshlrev_b32 v205, 4, v3
    v_add_u32 v205, s43, v205
    s_add_u32 s51, s63, 512
    s_lshl_b32 s51, s51, 11
    s_waitcnt lgkmcnt(0)
    s_barrier
    ds_read_b128 v[88:91], v205 offset:0
    s_lshr_b32 s42, s3, 1
    v_cmp_eq_u32 vcc, s42, v13
    s_waitcnt lgkmcnt(0)
    s_nop 0
    v_cndmask_b32 v88, 0, v88, vcc
    v_cndmask_b32 v89, 0, v89, vcc
    v_cndmask_b32 v90, 0, v90, vcc
    v_cndmask_b32 v91, 0, v91, vcc
    v_perm_b32 v72, v88, v88, v4
    v_perm_b32 v73, v88, v88, v5
    v_perm_b32 v74, v88, v88, v6
    v_perm_b32 v75, v88, v88, v7
    v_perm_b32 v76, v88, v88, v8
    v_perm_b32 v77, v88, v88, v9
    v_perm_b32 v78, v88, v88, v10
    v_perm_b32 v79, v88, v88, v11
    s_waitcnt vmcnt(7)
    v_mfma_f32_16x16x32_bf16 v[68:71], v[128:131], v[72:75], 0
    v_perm_b32 v72, v89, v89, v4
    v_perm_b32 v73, v89, v89, v5
    v_perm_b32 v74, v89, v89, v6
    v_perm_b32 v75, v89, v89, v7
    s_waitcnt vmcnt(6)
    v_mfma_f32_16x16x32_bf16 v[68:71], v[132:135], v[76:79], v[68:71]
    v_perm_b32 v76, v89, v89, v8
    v_perm_b32 v77, v89, v89, v9
    v_perm_b32 v78, v89, v89, v10
    v_perm_b32 v79, v89, v89, v11
    s_waitcnt vmcnt(5)
    v_mfma_f32_16x16x32_bf16 v[68:71], v[136:139], v[72:75], v[68:71]
    v_perm_b32 v72, v90, v90, v4
    v_perm_b32 v73, v90, v90, v5
    v_perm_b32 v74, v90, v90, v6
    v_perm_b32 v75, v90, v90, v7
    s_waitcnt vmcnt(4)
    v_mfma_f32_16x16x32_bf16 v[68:71], v[140:143], v[76:79], v[68:71]
    v_perm_b32 v76, v90, v90, v8
    v_perm_b32 v77, v90, v90, v9
    v_perm_b32 v78, v90, v90, v10
    v_perm_b32 v79, v90, v90, v11
    s_waitcnt vmcnt(3)
    v_mfma_f32_16x16x32_bf16 v[68:71], v[144:147], v[72:75], v[68:71]
    v_perm_b32 v72, v91, v91, v4
    v_perm_b32 v73, v91, v91, v5
    v_perm_b32 v74, v91, v91, v6
    v_perm_b32 v75, v91, v91, v7
    s_waitcnt vmcnt(2)
    v_mfma_f32_16x16x32_bf16 v[68:71], v[148:151], v[76:79], v[68:71]
    v_perm_b32 v76, v91, v91, v8
    v_perm_b32 v77, v91, v91, v9
    v_perm_b32 v78, v91, v91, v10
    v_perm_b32 v79, v91, v91, v11
    s_waitcnt vmcnt(1)
    v_mfma_f32_16x16x32_bf16 v[68:71], v[152:155], v[72:75], v[68:71]
    s_waitcnt vmcnt(0)
    v_mfma_f32_16x16x32_bf16 v[68:71], v[156:159], v[76:79], v[68:71]
    s_nop 7
    ds_write_b32 v14, v68 offset:4096
    ds_write_b32 v14, v69 offset:4128
    ds_write_b32 v14, v70 offset:4160
    ds_write_b32 v14, v71 offset:4192
    v_and_b32 v19, 3, v0
    v_lshlrev_b32 v19, 6, v19
    v_bfe_u32 v17, v0, 2, 5
    v_lshl_add_u32 v19, v17, 1, v19
    v_lshrrev_b32 v17, 7, v0
    v_lshl_add_u32 v19, v17, 8, v19
    v_add_u32 v19, 131072, v19
    v_lshl_add_u32 v205, v13, 8, v205
    s_waitcnt lgkmcnt(0)
    s_barrier
    ds_read_b32 v84, v15 offset:4096
    ds_read_b32 v85, v15 offset:5120
    ds_read_b32 v86, v15 offset:6144
    ds_read_b32 v87, v15 offset:7168
    s_waitcnt lgkmcnt(0)
    v_add_f32 v84, v84, v85
    v_add_f32 v86, v86, v87
    v_add_f32 v80, v84, v86
    v_cvt_pk_bf16_f32 v80, v80, v80
    ds_write_b16 v19, v80 offset:8192
    s_waitcnt lgkmcnt(0)
    s_barrier
    ds_read_b128 v[88:91], v205 offset:8192
    s_waitcnt lgkmcnt(0)
    v_perm_b32 v72, v88, v88, v4
    v_perm_b32 v73, v88, v88, v5
    v_perm_b32 v74, v88, v88, v6
    v_perm_b32 v75, v88, v88, v7
    v_perm_b32 v76, v88, v88, v8
    v_perm_b32 v77, v88, v88, v9
    v_perm_b32 v78, v88, v88, v10
    v_perm_b32 v79, v88, v88, v11
    v_mfma_f32_16x16x32_bf16 v[68:71], a[32:35], v[72:75], 0
    v_perm_b32 v72, v89, v89, v4
    v_perm_b32 v73, v89, v89, v5
    v_perm_b32 v74, v89, v89, v6
    v_perm_b32 v75, v89, v89, v7
    v_mfma_f32_16x16x32_bf16 v[68:71], a[36:39], v[76:79], v[68:71]
    v_perm_b32 v76, v89, v89, v8
    v_perm_b32 v77, v89, v89, v9
    v_perm_b32 v78, v89, v89, v10
    v_perm_b32 v79, v89, v89, v11
    v_mfma_f32_16x16x32_bf16 v[68:71], a[40:43], v[72:75], v[68:71]
    v_perm_b32 v72, v90, v90, v4
    v_perm_b32 v73, v90, v90, v5
    v_perm_b32 v74, v90, v90, v6
    v_perm_b32 v75, v90, v90, v7
    v_mfma_f32_16x16x32_bf16 v[68:71], a[44:47], v[76:79], v[68:71]
    v_perm_b32 v76, v90, v90, v8
    v_perm_b32 v77, v90, v90, v9
    v_perm_b32 v78, v90, v90, v10
    v_perm_b32 v79, v90, v90, v11
    v_mfma_f32_16x16x32_bf16 v[68:71], a[48:51], v[72:75], v[68:71]
    v_perm_b32 v72, v91, v91, v4
    v_perm_b32 v73, v91, v91, v5
    v_perm_b32 v74, v91, v91, v6
    v_perm_b32 v75, v91, v91, v7
    v_mfma_f32_16x16x32_bf16 v[68:71], a[52:55], v[76:79], v[68:71]
    v_perm_b32 v76, v91, v91, v8
    v_perm_b32 v77, v91, v91, v9
    v_perm_b32 v78, v91, v91, v10
    v_perm_b32 v79, v91, v91, v11
    v_mfma_f32_16x16x32_bf16 v[68:71], a[56:59], v[72:75], v[68:71]
    s_nop 0
    v_mfma_f32_16x16x32_bf16 v[68:71], a[60:63], v[76:79], v[68:71]
    s_nop 7
    ds_write_b32 v14, v68 offset:12288
    ds_write_b32 v14, v69 offset:12320
    ds_write_b32 v14, v70 offset:12352
    ds_write_b32 v14, v71 offset:12384
    v_mov_b32 v81, v12
    v_mov_b32 v92, 0
    v_mov_b32 v93, v12
    v_mov_b32 v94, 0x3e800000
    v_mov_b32 v95, v12
    v_lshrrev_b32 v17, 7, v0
    v_lshlrev_b32 v17, 6, v17
    s_lshl_b32 s42, s49, 7
    s_and_b32 s43, s63, 3
    s_lshl_b32 s43, s43, 4
    s_add_u32 s42, s42, s43
    s_add_u32 s42, s42, 1314816
    s_add_u32 s43, s42, 16777216
    v_and_b32 v18, 127, v0
    v_cmp_eq_u32 vcc, 0, v18
    s_nop 0
    s_and_saveexec_b64 s[32:33], vcc
    s_cbranch_execz L_b_noml2
    buffer_store_dwordx4 v[92:95], v17, s[4:7], s43 offen
    buffer_store_dwordx4 v[92:95], v17, s[4:7], s42 offen sc1
L_b_noml2:
    s_mov_b64 exec, s[32:33]
    s_waitcnt lgkmcnt(0)
    s_barrier
    ds_read_b32 v84, v15 offset:12288
    ds_read_b32 v85, v15 offset:13312
    ds_read_b32 v86, v15 offset:14336
    ds_read_b32 v87, v15 offset:15360
    s_waitcnt lgkmcnt(0)
    v_add_f32 v84, v84, v85
    v_add_f32 v86, v86, v87
    v_add_f32 v80, v84, v86
    s_add_u32 s42, s51, 16777216
    buffer_store_dwordx2 v[80:81], v16, s[4:7], s42 offen
    buffer_store_dwordx2 v[80:81], v16, s[4:7], s51 offen sc1
    s_add_u32 s53, s49, 32
L_stage4:
    s_lshl_b32 s51, s54, 18
    s_lshl_b32 s42, s49, 13
    s_add_u32 s51, s51, s42
    s_add_u32 s51, s51, 786432
    s_lshl_b32 s52, s54, 12
    s_lshl_b32 s42, s49, 7
    s_add_u32 s52, s52, s42
    s_add_u32 s52, s52, 1310720
    s_add_u32 s51, s51, s65
    s_add_u32 s52, s52, s65
    v_lshrrev_b32 v207, 7, v0
    v_lshlrev_b32 v207, 6, v207
    s_and_b32 s42, s63, 3
    s_cmp_eq_u32 s42, 3
    s_cbranch_scc1 L_final
    s_add_u32 s45, s51, 4096
    buffer_load_dwordx2 v[80:81], v16, s[4:7], s51 offen sc1
    buffer_load_dwordx2 v[82:83], v16, s[4:7], s51 offen offset:2048 sc1
    buffer_load_dwordx2 v[84:85], v16, s[4:7], s45 offen sc1
    buffer_load_dwordx2 v[86:87], v16, s[4:7], s45 offen offset:2048 sc1
    buffer_load_dwordx4 v[88:91], v207, s[4:7], s52 offen offset:0 sc1
    buffer_load_dwordx4 v[92:95], v207, s[4:7], s52 offen offset:16 sc1
    buffer_load_dwordx4 v[96:99], v207, s[4:7], s52 offen offset:32 sc1
    buffer_load_dwordx4 v[100:103], v207, s[4:7], s52 offen offset:48 sc1
    v_lshlrev_b32 v110, 1, v0
    v_add_u32 v110, 131072, v110
    s_lshl_b32 s42, s3, 6
    s_add_u32 s42, s42, 131072
    v_lshlrev_b32 v111, 4, v3
    v_lshl_add_u32 v111, v13, 8, v111
    v_add_u32 v111, s42, v111
    v_lshlrev_b32 v112, 10, v13
    v_lshl_add_u32 v112, v3, 7, v112
    v_and_b32 v17, 7, v1
    v_lshl_add_u32 v112, v17, 2, v112
    s_lshl_b32 s42, s3, 11
    s_add_u32 s42, s42, 131072
    v_add_u32 v112, s42, v112
    v_lshrrev_b32 v113, 7, v0
    v_and_b32 v114, 127, v0
    v_lshlrev_b32 v115, 10, v113
    v_lshl_add_u32 v115, v114, 3, v115
    v_add_u32 v115, 131072, v115
    v_mul_u32_u24 v116, 4608, v113
    v_lshl_add_u32 v116, v114, 4, v116
    s_lshl_b32 s42, s54, 5
    s_add_u32 s42, s42, s49
    s_mul_i32 s42, s42, 9216
    s_and_b32 s43, s63, 3
    s_mul_i32 s43, s43, 1536
    s_add_u32 s42, s42, s43
    s_add_u32 s50, s42, 1572864
    s_waitcnt vmcnt(0)
    s_mov_b32 s48, 3000000
L_chk_48:
    s_mov_b64 s[32:33], exec
    v_cmpx_eq_u32 vcc, v12, v81
    v_cmpx_eq_u32 vcc, v12, v83
    v_cmpx_eq_u32 vcc, v12, v85
    v_cmpx_eq_u32 vcc, v12, v87
    v_cmpx_eq_u32 vcc, v12, v89
    v_cmpx_eq_u32 vcc, v12, v91
    v_cmpx_eq_u32 vcc, v12, v93
    v_cmpx_eq_u32 vcc, v12, v95
    v_cmpx_eq_u32 vcc, v12, v97
    v_cmpx_eq_u32 vcc, v12, v99
    v_cmpx_eq_u32 vcc, v12, v101
    v_cmpx_eq_u32 vcc, v12, v103
    s_nop 3
    s_cmp_eq_u64 exec, s[32:33]
    s_mov_b64 exec, s[32:33]
    s_cbranch_scc1 L_ok_49
    s_sub_u32 s48, s48, 1
    s_cmp_eq_u32 s48, 0
    s_cbranch_scc1 L_to_50
    s_cmp_eq_u32 s48, 2999744
    s_cbranch_scc0 L_nf_51
    s_sub_u32 s51, s51, s65
    s_sub_u32 s52, s52, s65
    s_mov_b32 s65, 0
L_nf_51:
    s_add_u32 s45, s51, 4096
    buffer_load_dwordx2 v[80:81], v16, s[4:7], s51 offen sc1
    buffer_load_dwordx2 v[82:83], v16, s[4:7], s51 offen offset:2048 sc1
    buffer_load_dwordx2 v[84:85], v16, s[4:7], s45 offen sc1
    buffer_load_dwordx2 v[86:87], v16, s[4:7], s45 offen offset:2048 sc1
    buffer_load_dwordx4 v[88:91], v207, s[4:7], s52 offen offset:0 sc1
    buffer_load_dwordx4 v[92:95], v207, s[4:7], s52 offen offset:16 sc1
    buffer_load_dwordx4 v[96:99], v207, s[4:7], s52 offen offset:32 sc1
    buffer_load_dwordx4 v[100:103], v207, s[4:7], s52 offen offset:48 sc1
    s_waitcnt vmcnt(0)
    s_branch L_chk_48
L_to_50:
    s_mov_b32 s32, s60
    s_mov_b32 s33, s61
    s_mov_b32 s34, 256
    s_mov_b32 s35, 0x20000
    v_mov_b32 v17, 16
    v_mov_b32 v18, 1
    buffer_store_dword v18, v17, s[32:35], 0 offen
    s_waitcnt vmcnt(0)
L_ok_49:
    v_max3_f32 v104, v88, v92, v96
    v_max_f32 v104, v104, v100
    v_sub_f32 v88, v88, v104
    v_sub_f32 v92, v92, v104
    v_sub_f32 v96, v96, v104
    v_sub_f32 v100, v100, v104
    v_exp_f32 v88, v88
    v_exp_f32 v92, v92
    v_exp_f32 v96, v96
    v_exp_f32 v100, v100
    v_mul_f32 v105, v88, v80
    v_mul_f32 v106, v88, v90
    v_fmac_f32 v105, v92, v82
    v_fmac_f32 v106, v92, v94
    v_fmac_f32 v105, v96, v84
    v_fmac_f32 v106, v96, v98
    v_fmac_f32 v105, v100, v86
    v_fmac_f32 v106, v100, v102
    v_rcp_f32 v106, v106
    s_nop 0
    v_mul_f32 v105, v105, v106
    v_cvt_pk_bf16_f32 v105, v105, v105
    ds_write_b16 v110, v105 offset:16384
    s_waitcnt lgkmcnt(0)
    s_barrier
    ds_read_b128 v[88:91], v111 offset:16384
    s_waitcnt lgkmcnt(0)
    v_perm_b32 v72, v88, v88, v4
    v_perm_b32 v73, v88, v88, v5
    v_perm_b32 v74, v88, v88, v6
    v_perm_b32 v75, v88, v88, v7
    v_perm_b32 v76, v88, v88, v8
    v_perm_b32 v77, v88, v88, v9
    v_perm_b32 v78, v88, v88, v10
    v_perm_b32 v79, v88, v88, v11
    v_mfma_f32_16x16x32_bf16 v[68:71], a[128:131], v[72:75], 0
    v_mfma_f32_16x16x32_bf16 v[92:95], a[160:163], v[72:75], 0
    v_perm_b32 v72, v89, v89, v4
    v_perm_b32 v73, v89, v89, v5
    v_perm_b32 v74, v89, v89, v6
    v_perm_b32 v75, v89, v89, v7
    v_mfma_f32_16x16x32_bf16 v[68:71], a[132:135], v[76:79], v[68:71]
    v_mfma_f32_16x16x32_bf16 v[96:99], a[160:163], v[76:79], 0
    v_perm_b32 v76, v89, v89, v8
    v_perm_b32 v77, v89, v89, v9
    v_perm_b32 v78, v89, v89, v10
    v_perm_b32 v79, v89, v89, v11
    v_mfma_f32_16x16x32_bf16 v[68:71], a[136:139], v[72:75], v[68:71]
    v_mfma_f32_16x16x32_bf16 v[92:95], a[164:167], v[72:75], v[92:95]
    v_perm_b32 v72, v90, v90, v4
    v_perm_b32 v73, v90, v90, v5
    v_perm_b32 v74, v90, v90, v6
    v_perm_b32 v75, v90, v90, v7
    v_mfma_f32_16x16x32_bf16 v[68:71], a[140:143], v[76:79], v[68:71]
    v_mfma_f32_16x16x32_bf16 v[96:99], a[164:167], v[76:79], v[96:99]
    v_perm_b32 v76, v90, v90, v8
    v_perm_b32 v77, v90, v90, v9
    v_perm_b32 v78, v90, v90, v10
    v_perm_b32 v79, v90, v90, v11
    v_mfma_f32_16x16x32_bf16 v[68:71], a[144:147], v[72:75], v[68:71]
    v_mfma_f32_16x16x32_bf16 v[92:95], a[168:171], v[72:75], v[92:95]
    v_perm_b32 v72, v91, v91, v4
    v_perm_b32 v73, v91, v91, v5
    v_perm_b32 v74, v91, v91, v6
    v_perm_b32 v75, v91, v91, v7
    v_mfma_f32_16x16x32_bf16 v[68:71], a[148:151], v[76:79], v[68:71]
    v_mfma_f32_16x16x32_bf16 v[96:99], a[168:171], v[76:79], v[96:99]
    v_perm_b32 v76, v91, v91, v8
    v_perm_b32 v77, v91, v91, v9
    v_perm_b32 v78, v91, v91, v10
    v_perm_b32 v79, v91, v91, v11
    v_mfma_f32_16x16x32_bf16 v[68:71], a[152:155], v[72:75], v[68:71]
    v_mfma_f32_16x16x32_bf16 v[92:95], a[172:175], v[72:75], v[92:95]
    v_mfma_f32_16x16x32_bf16 v[68:71], a[156:159], v[76:79], v[68:71]
    v_mfma_f32_16x16x32_bf16 v[96:99], a[172:175], v[76:79], v[96:99]
    v_cmp_gt_u32 vcc, 32, v1
    s_nop 5
    ds_write_b32 v112, v68 offset:20480
    ds_write_b32 v112, v69 offset:20512
    ds_write_b32 v112, v70 offset:20544
    ds_write_b32 v112, v71 offset:20576
    v_cndmask_b32 v92, v96, v92, vcc
    v_cndmask_b32 v93, v97, v93, vcc
    v_cndmask_b32 v94, v98, v94, vcc
    v_cndmask_b32 v95, v99, v95, vcc
    ds_write_b32 v112, v92 offset:20992
    ds_write_b32 v112, v93 offset:21024
    ds_write_b32 v112, v94 offset:21056
    ds_write_b32 v112, v95 offset:21088
    s_waitcnt lgkmcnt(0)
    s_barrier
    ds_read_b64 v[80:81], v115 offset:20480
    ds_read_b64 v[88:89], v115 offset:20736
    ds_read_b64 v[82:83], v115 offset:22528
    ds_read_b64 v[90:91], v115 offset:22784
    ds_read_b64 v[84:85], v115 offset:24576
    ds_read_b64 v[92:93], v115 offset:24832
    ds_read_b64 v[86:87], v115 offset:26624
    ds_read_b64 v[94:95], v115 offset:26880
    v_cmp_le_u32 vcc, 64, v114
    v_mov_b32 v101, v12
    v_mov_b32 v103, v12
    s_waitcnt lgkmcnt(0)
    v_add_f32 v80, v80, v82
    v_add_f32 v84, v84, v86
    v_add_f32 v88, v88, v90
    v_add_f32 v92, v92, v94
    v_add_f32 v80, v80, v84
    v_add_f32 v88, v88, v92
    v_cndmask_b32 v88, 0, v88, vcc
    v_add_f32 v100, v80, v88
    v_add_f32 v81, v81, v83
    v_add_f32 v85, v85, v87
    v_add_f32 v89, v89, v91
    v_add_f32 v93, v93, v95
    v_add_f32 v81, v81, v85
    v_add_f32 v89, v89, v93
    v_cndmask_b32 v89, 0, v89, vcc
    v_add_f32 v102, v81, v89
    v_cmp_gt_u32 vcc, 96, v114
    s_nop 0
    s_and_saveexec_b64 s[32:33], vcc
    buffer_store_dwordx4 v[100:103], v116, s[4:7], s50 offen sc1
    s_mov_b64 exec, s[32:33]
    s_branch L_done
L_final:
    s_cmp_ge_u32 s53, 36
    s_cbranch_scc1 L_done
    s_cmp_ge_u32 s53, 18
    s_cselect_b32 s42, 1, 0
    s_cselect_b32 s43, 18, 0
    s_sub_u32 s43, s53, s43
    s_mul_i32 s44, s42, 4608
    s_lshl_b32 s45, s43, 8
    s_add_u32 s44, s44, s45
    s_mul_i32 s45, s3, 147456
    s_add_u32 s50, s44, s45
    s_add_u32 s50, s50, 1572864
    v_mul_u32_u24 v204, 9216, v3
    v_lshl_add_u32 v204, v2, 4, v204
    s_mul_i32 s51, s42, 2304
    s_lshl_b32 s43, s43, 6
    s_add_u32 s51, s51, s43
    s_lshl_b32 s42, s3, 7
    s_add_u32 s42, s42, 131072
    v_lshlrev_b32 v110, 3, v2
    v_add_u32 v110, s42, v110
    v_lshlrev_b32 v111, 8, v3
    v_lshl_add_u32 v111, v2, 3, v111
    v_add_u32 v111, 131072, v111
    v_mul_u32_u24 v112, 1152, v3
    v_lshl_add_u32 v112, v2, 2, v112
    s_mov_b32 s48, 256
    v_mov_b32 v120, 0
    buffer_load_dword v121, v120, s[8:11], 0 offen
    s_add_u32 s45, s50, 0
    buffer_load_dwordx4 v[128:131], v204, s[4:7], s45 offen sc1
    s_add_u32 s45, s50, 36864
    buffer_load_dwordx4 v[132:135], v204, s[4:7], s45 offen sc1
    s_add_u32 s45, s50, 73728
    buffer_load_dwordx4 v[136:139], v204, s[4:7], s45 offen sc1
    s_add_u32 s45, s50, 110592
    buffer_load_dwordx4 v[140:143], v204, s[4:7], s45 offen sc1
    s_waitcnt vmcnt(4)
    s_add_u32 s45, s50, 0
    buffer_load_dwordx4 v[144:147], v204, s[4:7], s45 offen sc1
    s_add_u32 s45, s50, 36864
    buffer_load_dwordx4 v[148:151], v204, s[4:7], s45 offen sc1
    s_add_u32 s45, s50, 73728
    buffer_load_dwordx4 v[152:155], v204, s[4:7], s45 offen sc1
    s_add_u32 s45, s50, 110592
    buffer_load_dwordx4 v[156:159], v204, s[4:7], s45 offen sc1
L_pa_52:
    s_waitcnt vmcnt(4)
    s_mov_b64 s[32:33], exec
    v_cmpx_eq_u32 vcc, v12, v129
    v_cmpx_eq_u32 vcc, v12, v131
    v_cmpx_eq_u32 vcc, v12, v133
    v_cmpx_eq_u32 vcc, v12, v135
    v_cmpx_eq_u32 vcc, v12, v137
    v_cmpx_eq_u32 vcc, v12, v139
    v_cmpx_eq_u32 vcc, v12, v141
    v_cmpx_eq_u32 vcc, v12, v143
    s_nop 3
    s_cmp_eq_u64 exec, s[32:33]
    s_mov_b64 exec, s[32:33]
    s_cbranch_scc1 L_oka_53
    s_add_u32 s45, s50, 0
    buffer_load_dwordx4 v[128:131], v204, s[4:7], s45 offen sc1
    s_add_u32 s45, s50, 36864
    buffer_load_dwordx4 v[132:135], v204, s[4:7], s45 offen sc1
    s_add_u32 s45, s50, 73728
    buffer_load_dwordx4 v[136:139], v204, s[4:7], s45 offen sc1
    s_add_u32 s45, s50, 110592
    buffer_load_dwordx4 v[140:143], v204, s[4:7], s45 offen sc1
    s_waitcnt vmcnt(4)
    s_mov_b64 s[32:33], exec
    v_cmpx_eq_u32 vcc, v12, v145
    v_cmpx_eq_u32 vcc, v12, v147
    v_cmpx_eq_u32 vcc, v12, v149
    v_cmpx_eq_u32 vcc, v12, v151
    v_cmpx_eq_u32 vcc, v12, v153
    v_cmpx_eq_u32 vcc, v12, v155
    v_cmpx_eq_u32 vcc, v12, v157
    v_cmpx_eq_u32 vcc, v12, v159
    s_nop 3
    s_cmp_eq_u64 exec, s[32:33]
    s_mov_b64 exec, s[32:33]
    s_cbranch_scc1 L_okb_54
    s_add_u32 s45, s50, 0
    buffer_load_dwordx4 v[144:147], v204, s[4:7], s45 offen sc1
    s_add_u32 s45, s50, 36864
    buffer_load_dwordx4 v[148:151], v204, s[4:7], s45 offen sc1
    s_add_u32 s45, s50, 73728
    buffer_load_dwordx4 v[152:155], v204, s[4:7], s45 offen sc1
    s_add_u32 s45, s50, 110592
    buffer_load_dwordx4 v[156:159], v204, s[4:7], s45 offen sc1
    s_sub_u32 s48, s48, 1
    s_cmp_eq_u32 s48, 0
    s_cbranch_scc0 L_pa_52
    s_mov_b32 s48, 6000000
L_ps_55:
    s_waitcnt vmcnt(0)
    s_mov_b64 s[32:33], exec
    v_cmpx_eq_u32 vcc, v12, v129
    v_cmpx_eq_u32 vcc, v12, v131
    v_cmpx_eq_u32 vcc, v12, v133
    v_cmpx_eq_u32 vcc, v12, v135
    v_cmpx_eq_u32 vcc, v12, v137
    v_cmpx_eq_u32 vcc, v12, v139
    v_cmpx_eq_u32 vcc, v12, v141
    v_cmpx_eq_u32 vcc, v12, v143
    s_nop 3
    s_cmp_eq_u64 exec, s[32:33]
    s_mov_b64 exec, s[32:33]
    s_cbranch_scc1 L_oka_53
    s_add_u32 s45, s50, 0
    buffer_load_dwordx4 v[128:131], v204, s[4:7], s45 offen sc1
    s_add_u32 s45, s50, 36864
    buffer_load_dwordx4 v[132:135], v204, s[4:7], s45 offen sc1
    s_add_u32 s45, s50, 73728
    buffer_load_dwordx4 v[136:139], v204, s[4:7], s45 offen sc1
    s_add_u32 s45, s50, 110592
    buffer_load_dwordx4 v[140:143], v204, s[4:7], s45 offen sc1
    s_sub_u32 s48, s48, 1
    s_cmp_eq_u32 s48, 0
    s_cbranch_scc0 L_ps_55
    s_waitcnt vmcnt(0)
    s_mov_b32 s32, s60
    s_mov_b32 s33, s61
    s_mov_b32 s34, 256
    s_mov_b32 s35, 0x20000
    v_mov_b32 v17, 20
    v_mov_b32 v18, 1
    buffer_store_dword v18, v17, s[32:35], 0 offen
    s_waitcnt vmcnt(0)
L_oka_53:
    v_add_f32 v128, v128, v132
    v_add_f32 v136, v136, v140
    v_add_f32 v130, v130, v134
    v_add_f32 v138, v138, v142
    v_add_f32 v80, v128, v136
    v_add_f32 v81, v130, v138
    s_branch L_pd_56
L_okb_54:
    v_add_f32 v144, v144, v148
    v_add_f32 v152, v152, v156
    v_add_f32 v146, v146, v150
    v_add_f32 v154, v154, v158
    v_add_f32 v80, v144, v152
    v_add_f32 v81, v146, v154
L_pd_56:
    v_mov_b32 v17, v80
    s_nop 1
    v_permlane16_swap_b32 v80, v17
    v_add_f32 v80, v80, v17
    v_mov_b32 v17, v80
    s_nop 1
    v_permlane32_swap_b32 v80, v17
    v_add_f32 v80, v80, v17
    v_mov_b32 v18, v81
    s_nop 1
    v_permlane16_swap_b32 v81, v18
    v_add_f32 v81, v81, v18
    v_mov_b32 v18, v81
    s_nop 1
    v_permlane32_swap_b32 v81, v18
    v_add_f32 v81, v81, v18
    v_cmp_gt_u32 vcc, 16, v1
    s_nop 0
    s_and_saveexec_b64 s[32:33], vcc
    ds_write_b64 v110, v[80:81] offset:28672
    s_mov_b64 exec, s[32:33]
    s_waitcnt lgkmcnt(0)
    s_barrier
    v_cmp_gt_u32 vcc, 32, v0
    s_nop 0
    s_and_saveexec_b64 s[32:33], vcc
    s_cbranch_execz L_f_skip
    ds_read_b64 v[80:81], v111 offset:28672
    ds_read_b64 v[82:83], v111 offset:28800
    s_waitcnt lgkmcnt(0)
    v_add_f32 v80, v80, v82
    v_add_f32 v81, v81, v83
    v_cvt_pk_bf16_f32 v80, v80, v81
    buffer_store_dword v80, v112, s[28:31], s51 offen
    s_cmp_lg_u32 s53, 0
    s_cbranch_scc1 L_f_skip
    v_mov_b32 v17, 0
    v_cmp_eq_u32 vcc, 0, v0
    s_nop 0
    s_and_b64 exec, exec, vcc
    buffer_store_dword v12, v17, s[4:7], 0 offen sc1
L_f_skip:
    s_mov_b64 exec, s[32:33]
L_done:
L_end:
    s_endpgm

.section .rodata,"a"
.p2align 6
.amdhsa_kernel concat_heads__sliding_block_cached__compressed_kv_cla__decode_kernel
  .amdhsa_next_free_vgpr 512
  .amdhsa_next_free_sgpr 102
  .amdhsa_accum_offset 256
  .amdhsa_group_segment_fixed_size 0
  .amdhsa_kernarg_size 112
  .amdhsa_user_sgpr_count 2
  .amdhsa_user_sgpr_kernarg_segment_ptr 1
  .amdhsa_system_sgpr_workgroup_id_x 1
.end_amdhsa_kernel
```
